```python
import torch

def _softmax(x, axis=-1):
    return torch.softmax(x, dim=axis)
def _gelu(x):
    return torch.nn.functional.gelu(x, approximate="tanh")
def _silu(x):
    return torch.nn.functional.silu(x)
def _sigmoid(x):
    return torch.sigmoid(x)
def _layernorm(x, axis=-1, eps=1e-5):
    m = x.mean(dim=axis, keepdim=True)
    v = x.var(dim=axis, keepdim=True, unbiased=False)
    return (x - m) / torch.sqrt(v + eps)
def _scatter_add(tgt, idx, src, axis=0):
    return tgt.clone().index_add_(axis, idx, src)
def _segment_sum(src, seg, n):
    out = torch.zeros((n,) + src.shape[1:], dtype=src.dtype)
    return out.index_add_(0, seg, src)
def _pad(x, pw):
    flat = tuple(v for pair in reversed(pw) for v in pair)
    return torch.nn.functional.pad(x, flat)

kernel_name = 'standalone__edge_featured_mpnn_mpnn__graph'

def setup_inputs():

    _w = (lambda a: (lambda t: t.to(torch.bfloat16) if t.is_floating_point() else t)(torch.as_tensor(a)))
    N, deg, D, De = 10000, 16, 128, max(16, 1)
    E = N * deg
    H = 2 * D
    return {
        "x": _w((lambda *s: torch.randn(*s, dtype=torch.bfloat16) * 0.05)(N, D)),
        "e_attr": _w((lambda *s: torch.randn(*s, dtype=torch.bfloat16) * 0.8)(E, De)),
        "src": _w((lambda lo, hi, *s: torch.randint(lo, hi, s))(0, N, E).to(torch.int64)),
        "dst": _w((lambda lo, hi, *s: torch.randint(lo, hi, s))(0, N, E).to(torch.int64)),
        "w1": _w((lambda *s: torch.randn(*s, dtype=torch.bfloat16) * 0.8)(2 * D + De, H) * (1.0 / (2 * D + De) ** 0.5)),
        "b1": _w((lambda *s: torch.randn(*s, dtype=torch.bfloat16) * 0.4)(H) * 0.01),
        "w2": _w((lambda *s: torch.randn(*s, dtype=torch.bfloat16) * 0.05)(H, D) * (1.0 / H ** 0.5)),
        "b2": _w((lambda *s: torch.randn(*s, dtype=torch.bfloat16) * 0.05)(D) * 0.01),
    }

def reference(x, e_attr, src, dst, w1, b1, w2, b2):
    N, D = x.shape
    h_src = x[src]
    h_dst = x[dst]
    m_in = torch.concatenate([h_src, h_dst, e_attr], axis=-1)
    h = _silu(m_in @ w1 + b1)
    msg = h @ w2 + b2
    return _segment_sum(msg, dst, N)
```

```asm
; @launch kernel=k1_bin_prep_kernel grid=(255,1,1) block=(512,1,1) lds=81920
; @launch kernel=k2_main_kernel grid=(512,1,1) block=(256,1,1) lds=68864
.amdgcn_target "amdgcn-amd-amdhsa--gfx950"
.text
.globl k1_bin_prep_kernel
.p2align 8
.type k1_bin_prep_kernel,@function
k1_bin_prep_kernel:
    s_cmp_ge_u32 s2, 255
    s_cbranch_scc1 K1_EXIT
    s_load_dwordx2 s[4:5], s[0:1], 80
    s_cmp_ge_u32 s2, 80
    s_cbranch_scc1 K1_NOBIN
    s_load_dwordx4 s[8:11], s[0:1], 16
    v_lshlrev_b32 v1, 4, v0
    v_mov_b32 v4, -1
    v_mov_b32 v5, -1
    v_mov_b32 v6, -1
    v_mov_b32 v7, -1
    v_lshlrev_b32 v2, 2, v0
    v_mov_b32 v3, 0
    ds_write_b128 v1, v[4:7] offset:0
    ds_write_b128 v1, v[4:7] offset:8192
    ds_write_b128 v1, v[4:7] offset:16384
    ds_write_b128 v1, v[4:7] offset:24576
    ds_write_b32 v2, v3 offset:32768
    s_mul_i32 s3, s2, 8000
    s_waitcnt lgkmcnt(0)
    s_add_u32 s12, s8, s3
    s_addc_u32 s13, s9, 0
    s_mov_b32 s14, 8000
    s_mov_b32 s15, 0x00020000
    s_add_u32 s16, s10, s3
    s_addc_u32 s17, s11, 0
    s_mov_b32 s18, 8000
    s_mov_b32 s19, 0x00020000
    buffer_load_dwordx4 v[8:11], v1, s[16:19], 0 offen
    buffer_load_dwordx4 v[12:15], v1, s[12:15], 0 offen
    s_mov_b32 s20, s4
    s_mov_b32 s21, s5
    s_mov_b32 s22, 2883584
    s_mov_b32 s23, 0x00020000
    s_mov_b32 s24, 429497
    s_movk_i32 s25, 625
    s_barrier
    v_cmp_gt_u32 vcc, 500, v0
    s_and_saveexec_b64 s[26:27], vcc
    s_cbranch_execz K1_BIN_SKIP
    v_mov_b32 v3, 1
    s_waitcnt vmcnt(1)
    v_mul_u32_u24 v16, s24, v8
    v_mul_u32_u24 v17, s24, v9
    v_mul_u32_u24 v18, s24, v10
    v_mul_u32_u24 v19, s24, v11
    v_lshrrev_b32 v16, 23, v16
    v_lshrrev_b32 v17, 23, v17
    v_lshrrev_b32 v18, 23, v18
    v_lshrrev_b32 v19, 23, v19
    v_lshlrev_b32 v20, 2, v16
    v_lshlrev_b32 v21, 2, v17
    v_lshlrev_b32 v22, 2, v18
    v_lshlrev_b32 v23, 2, v19
    ds_add_rtn_u32 v24, v20, v3 offset:32768
    ds_add_rtn_u32 v25, v21, v3 offset:32768
    ds_add_rtn_u32 v26, v22, v3 offset:32768
    ds_add_rtn_u32 v27, v23, v3 offset:32768
    v_mad_u32_u24 v28, v16, s25, 31
    v_mad_u32_u24 v29, v17, s25, 31
    v_mad_u32_u24 v30, v18, s25, 31
    v_mad_u32_u24 v31, v19, s25, 31
    v_lshrrev_b32 v28, 5, v28
    v_lshrrev_b32 v29, 5, v29
    v_lshrrev_b32 v30, 5, v30
    v_lshrrev_b32 v31, 5, v31
    v_sub_u32 v28, v8, v28
    v_sub_u32 v29, v9, v29
    v_sub_u32 v30, v10, v30
    v_sub_u32 v31, v11, v31
    v_lshlrev_b32 v2, 21, v0
    s_waitcnt vmcnt(0)
    v_lshl_or_b32 v28, v28, 14, v12
    v_lshl_or_b32 v29, v29, 14, v13
    v_lshl_or_b32 v30, v30, 14, v14
    v_lshl_or_b32 v31, v31, 14, v15
    v_or_b32 v28, v28, v2
    v_or_b32 v29, v29, v2
    v_add_u32 v29, 524288, v29
    v_or_b32 v30, v30, v2
    v_add_u32 v30, 1048576, v30
    v_or_b32 v31, v31, v2
    v_add_u32 v31, 1572864, v31
    v_lshlrev_b32 v16, 6, v16
    v_lshlrev_b32 v17, 6, v17
    v_lshlrev_b32 v18, 6, v18
    v_lshlrev_b32 v19, 6, v19
    v_mov_b32 v3, 34816
    s_waitcnt lgkmcnt(0)
    v_lshl_add_u32 v16, v24, 2, v16
    v_cmp_gt_u32 vcc, 16, v24
    s_nop 1
    v_cndmask_b32 v16, v3, v16, vcc
    ds_write_b32 v16, v28
    v_lshl_add_u32 v17, v25, 2, v17
    v_cmp_gt_u32 vcc, 16, v25
    s_nop 1
    v_cndmask_b32 v17, v3, v17, vcc
    ds_write_b32 v17, v29
    v_lshl_add_u32 v18, v26, 2, v18
    v_cmp_gt_u32 vcc, 16, v26
    s_nop 1
    v_cndmask_b32 v18, v3, v18, vcc
    ds_write_b32 v18, v30
    v_lshl_add_u32 v19, v27, 2, v19
    v_cmp_gt_u32 vcc, 16, v27
    s_nop 1
    v_cndmask_b32 v19, v3, v19, vcc
    ds_write_b32 v19, v31
K1_BIN_SKIP:
    s_mov_b64 exec, s[26:27]
    s_waitcnt lgkmcnt(0)
    s_barrier
    v_lshrrev_b32 v2, 2, v0
    v_lshlrev_b32 v3, 2, v2
    ds_read_b128 v[8:11], v1 offset:0
    ds_read_b32 v24, v3 offset:32768
    ds_read_b128 v[12:15], v1 offset:8192
    ds_read_b32 v25, v3 offset:33280
    ds_read_b128 v[16:19], v1 offset:16384
    ds_read_b32 v26, v3 offset:33792
    ds_read_b128 v[20:23], v1 offset:24576
    ds_read_b32 v27, v3 offset:34304
    s_movk_i32 s25, 5120
    v_mul_u32_u24 v2, s25, v2
    v_and_b32 v3, 3, v0
    v_lshl_add_u32 v2, v3, 4, v2
    s_lshl_b32 s3, s2, 6
    s_add_u32 s3, s3, 262144
    v_mov_b32 v4, -2
    s_waitcnt lgkmcnt(6)
    v_cmp_lt_u32 vcc, 16, v24
    s_nop 1
    v_cndmask_b32 v8, v8, v4, vcc
    v_cndmask_b32 v9, v9, v4, vcc
    v_cndmask_b32 v10, v10, v4, vcc
    v_cndmask_b32 v11, v11, v4, vcc
    buffer_store_dwordx4 v[8:11], v2, s[20:23], s3 offen
    s_add_u32 s3, s3, 655360
    s_waitcnt lgkmcnt(4)
    v_cmp_lt_u32 vcc, 16, v25
    s_nop 1
    v_cndmask_b32 v12, v12, v4, vcc
    v_cndmask_b32 v13, v13, v4, vcc
    v_cndmask_b32 v14, v14, v4, vcc
    v_cndmask_b32 v15, v15, v4, vcc
    buffer_store_dwordx4 v[12:15], v2, s[20:23], s3 offen
    s_add_u32 s3, s3, 655360
    s_waitcnt lgkmcnt(2)
    v_cmp_lt_u32 vcc, 16, v26
    s_nop 1
    v_cndmask_b32 v16, v16, v4, vcc
    v_cndmask_b32 v17, v17, v4, vcc
    v_cndmask_b32 v18, v18, v4, vcc
    v_cndmask_b32 v19, v19, v4, vcc
    buffer_store_dwordx4 v[16:19], v2, s[20:23], s3 offen
    s_add_u32 s3, s3, 655360
    s_waitcnt lgkmcnt(0)
    v_cmp_lt_u32 vcc, 16, v27
    s_nop 1
    v_cndmask_b32 v20, v20, v4, vcc
    v_cndmask_b32 v21, v21, v4, vcc
    v_cndmask_b32 v22, v22, v4, vcc
    v_cndmask_b32 v23, v23, v4, vcc
    buffer_store_dwordx4 v[20:23], v2, s[20:23], s3 offen
    s_endpgm
K1_NOBIN:
    s_cmp_ge_u32 s2, 237
    s_cbranch_scc1 K1_PREP
    s_load_dwordx2 s[8:9], s[0:1], 0
    s_load_dwordx2 s[10:11], s[0:1], 32
    v_and_b32 v1, 63, v0
    v_lshrrev_b32 v2, 6, v0
    s_sub_u32 s3, s2, 80
    v_readfirstlane_b32 s6, v2
    s_lshl_b32 s3, s3, 6
    v_lshrrev_b32 v3, 4, v1
    s_lshl_b32 s7, s6, 3
    v_add_u32 v4, s7, v3
    v_add_u32 v5, 4, v4
    v_and_b32 v6, 15, v1
    v_and_b32 v7, 15, v4
    v_xor_b32 v7, v7, v6
    v_add_u32 v4, s3, v4
    v_lshlrev_b32 v4, 8, v4
    v_lshl_add_u32 v4, v7, 4, v4
    v_and_b32 v7, 15, v5
    v_xor_b32 v7, v7, v6
    v_add_u32 v5, s3, v5
    v_lshlrev_b32 v5, 8, v5
    v_lshl_add_u32 v5, v7, 4, v5
    v_lshrrev_b32 v6, 5, v1
    v_and_b32 v7, 31, v1
    v_lshlrev_b32 v8, 2, v6
    v_xor_b32 v7, v7, v8
    v_lshlrev_b32 v7, 4, v7
    v_lshl_add_u32 v8, v6, 9, v7
    v_xor_b32 v9, 128, v8
    s_waitcnt lgkmcnt(0)
    s_mov_b32 s12, s8
    s_mov_b32 s13, s9
    s_mov_b32 s14, 2560000
    s_mov_b32 s15, 0x00020000
    s_mov_b32 s16, s10
    s_mov_b32 s17, s11
    s_mov_b32 s18, 65536
    s_mov_b32 s19, 0x00020000
    s_add_u32 s20, s4, 2883584
    s_addc_u32 s21, s5, 0
    s_mov_b32 s22, 5120000
    s_mov_b32 s23, 0x00020000
    s_lshl_b32 s7, s6, 11
    s_add_u32 m0, s7, 65536
    s_lshl_b32 s24, s6, 13
    buffer_load_dwordx4 v4, s[12:15], 0 offen lds
    s_add_u32 m0, s7, 66560
    s_nop 0
    buffer_load_dwordx4 v5, s[12:15], 0 offen lds
    s_add_u32 s25, s24, 0
    s_mov_b32 m0, s25
    s_nop 0
    buffer_load_dwordx4 v8, s[16:19], s25 offen lds
    s_add_u32 s25, s24, 1024
    s_mov_b32 m0, s25
    s_nop 0
    buffer_load_dwordx4 v9, s[16:19], s25 offen lds
    s_add_u32 s25, s24, 2048
    s_mov_b32 m0, s25
    s_nop 0
    buffer_load_dwordx4 v8, s[16:19], s25 offen lds
    s_add_u32 s25, s24, 3072
    s_mov_b32 m0, s25
    s_nop 0
    buffer_load_dwordx4 v9, s[16:19], s25 offen lds
    s_add_u32 s25, s24, 4096
    s_mov_b32 m0, s25
    s_nop 0
    buffer_load_dwordx4 v8, s[16:19], s25 offen lds
    s_add_u32 s25, s24, 5120
    s_mov_b32 m0, s25
    s_nop 0
    buffer_load_dwordx4 v9, s[16:19], s25 offen lds
    s_add_u32 s25, s24, 6144
    s_mov_b32 m0, s25
    s_nop 0
    buffer_load_dwordx4 v8, s[16:19], s25 offen lds
    s_add_u32 s25, s24, 7168
    s_mov_b32 m0, s25
    s_nop 0
    buffer_load_dwordx4 v9, s[16:19], s25 offen lds
    v_bfe_u32 v10, v1, 2, 2
    v_lshl_add_u32 v11, v6, 3, v10
    v_lshlrev_b32 v11, 9, v11
    v_and_b32 v12, 1, v1
    v_lshlrev_b32 v12, 1, v12
    v_bfe_u32 v13, v1, 4, 1
    v_or_b32 v12, v12, v13
    s_lshl_b32 s7, s6, 2
    v_or_b32 v12, s7, v12
    v_lshlrev_b32 v10, 2, v10
    v_xor_b32 v12, v12, v10
    v_lshl_add_u32 v11, v12, 4, v11
    v_bfe_u32 v13, v1, 1, 1
    v_lshl_add_u32 v11, v13, 3, v11
    v_and_b32 v12, 31, v1
    v_and_b32 v13, 15, v1
    v_xor_b32 v13, v13, v6
    v_lshlrev_b32 v13, 4, v13
    v_lshl_add_u32 v13, v12, 8, v13
    v_add_u32 v16, 0x10000, v13
    v_xor_b32 v17, 32, v16
    v_xor_b32 v18, 64, v16
    v_xor_b32 v19, 96, v16
    v_xor_b32 v20, 128, v16
    v_xor_b32 v21, 160, v16
    v_xor_b32 v22, 192, v16
    v_xor_b32 v23, 224, v16
    v_add_u32 v14, s3, v12
    v_lshlrev_b32 v14, 9, v14
    v_lshl_add_u32 v14, v6, 5, v14
    s_lshl_b32 s7, s6, 6
    v_add_u32 v14, s7, v14
    s_mov_b32 s7, 0xbfb8aa3b
    s_waitcnt vmcnt(0)
    s_barrier
    ds_read_b64_tr_b16 v[24:25], v11 offset:0
    ds_read_b64_tr_b16 v[26:27], v11 offset:2048
    ds_read_b128 v[56:59], v16
    ds_read_b64_tr_b16 v[28:29], v11 offset:8192
    ds_read_b64_tr_b16 v[30:31], v11 offset:10240
    ds_read_b128 v[60:63], v17
    ds_read_b64_tr_b16 v[32:33], v11 offset:16384
    ds_read_b64_tr_b16 v[34:35], v11 offset:18432
    ds_read_b128 v[64:67], v18
    ds_read_b64_tr_b16 v[36:37], v11 offset:24576
    ds_read_b64_tr_b16 v[38:39], v11 offset:26624
    ds_read_b128 v[68:71], v19
    ds_read_b64_tr_b16 v[40:41], v11 offset:32768
    ds_read_b64_tr_b16 v[42:43], v11 offset:34816
    ds_read_b128 v[72:75], v20
    ds_read_b64_tr_b16 v[44:45], v11 offset:40960
    ds_read_b64_tr_b16 v[46:47], v11 offset:43008
    ds_read_b128 v[76:79], v21
    ds_read_b64_tr_b16 v[48:49], v11 offset:49152
    ds_read_b64_tr_b16 v[50:51], v11 offset:51200
    ds_read_b128 v[80:83], v22
    ds_read_b64_tr_b16 v[52:53], v11 offset:57344
    ds_read_b64_tr_b16 v[54:55], v11 offset:59392
    ds_read_b128 v[84:87], v23
    ds_read_b128 v[88:91], v16 offset:8192
    ds_read_b128 v[92:95], v17 offset:8192
    ds_read_b128 v[96:99], v18 offset:8192
    ds_read_b128 v[100:103], v19 offset:8192
    s_waitcnt lgkmcnt(15)
    v_mfma_f32_32x32x16_bf16 v[120:135], v[24:27], v[56:59], 0
    s_waitcnt lgkmcnt(15)
    v_mfma_f32_32x32x16_bf16 v[120:135], v[28:31], v[60:63], v[120:135]
    s_waitcnt lgkmcnt(15)
    v_mfma_f32_32x32x16_bf16 v[120:135], v[32:35], v[64:67], v[120:135]
    s_waitcnt lgkmcnt(15)
    v_mfma_f32_32x32x16_bf16 v[120:135], v[36:39], v[68:71], v[120:135]
    s_waitcnt lgkmcnt(13)
    v_mfma_f32_32x32x16_bf16 v[120:135], v[40:43], v[72:75], v[120:135]
    s_waitcnt lgkmcnt(10)
    v_mfma_f32_32x32x16_bf16 v[120:135], v[44:47], v[76:79], v[120:135]
    s_waitcnt lgkmcnt(7)
    v_mfma_f32_32x32x16_bf16 v[120:135], v[48:51], v[80:83], v[120:135]
    s_waitcnt lgkmcnt(4)
    v_mfma_f32_32x32x16_bf16 v[120:135], v[52:55], v[84:87], v[120:135]
    ds_read_b128 v[104:107], v20 offset:8192
    ds_read_b128 v[108:111], v21 offset:8192
    ds_read_b128 v[112:115], v22 offset:8192
    ds_read_b128 v[116:119], v23 offset:8192
    s_waitcnt lgkmcnt(4)
    v_mfma_f32_32x32x16_bf16 v[136:151], v[24:27], v[88:91], 0
    v_mfma_f32_32x32x16_bf16 v[136:151], v[28:31], v[92:95], v[136:151]
    v_mfma_f32_32x32x16_bf16 v[136:151], v[32:35], v[96:99], v[136:151]
    v_mfma_f32_32x32x16_bf16 v[136:151], v[36:39], v[100:103], v[136:151]
    s_waitcnt lgkmcnt(3)
    v_mfma_f32_32x32x16_bf16 v[136:151], v[40:43], v[104:107], v[136:151]
    s_waitcnt lgkmcnt(2)
    v_mfma_f32_32x32x16_bf16 v[136:151], v[44:47], v[108:111], v[136:151]
    s_waitcnt lgkmcnt(1)
    v_mfma_f32_32x32x16_bf16 v[136:151], v[48:51], v[112:115], v[136:151]
    s_waitcnt lgkmcnt(0)
    v_mfma_f32_32x32x16_bf16 v[136:151], v[52:55], v[116:119], v[136:151]
    v_mul_f32 v120, s7, v120
    v_mul_f32 v121, s7, v121
    v_mul_f32 v122, s7, v122
    v_mul_f32 v123, s7, v123
    v_mul_f32 v124, s7, v124
    v_mul_f32 v125, s7, v125
    v_mul_f32 v126, s7, v126
    v_mul_f32 v127, s7, v127
    v_mul_f32 v128, s7, v128
    v_mul_f32 v129, s7, v129
    v_mul_f32 v130, s7, v130
    v_mul_f32 v131, s7, v131
    v_mul_f32 v132, s7, v132
    v_mul_f32 v133, s7, v133
    v_mul_f32 v134, s7, v134
    v_mul_f32 v135, s7, v135
    v_cvt_pk_bf16_f32 v56, v120, v121
    v_cvt_pk_bf16_f32 v57, v122, v123
    v_cvt_pk_bf16_f32 v58, v124, v125
    v_cvt_pk_bf16_f32 v59, v126, v127
    v_cvt_pk_bf16_f32 v60, v128, v129
    v_cvt_pk_bf16_f32 v61, v130, v131
    v_cvt_pk_bf16_f32 v62, v132, v133
    v_cvt_pk_bf16_f32 v63, v134, v135
    buffer_store_dwordx4 v[56:59], v14, s[20:23], 0 offen
    buffer_store_dwordx4 v[60:63], v14, s[20:23], 0 offen offset:16
    s_nop 7
    s_nop 3
    v_mul_f32 v136, s7, v136
    v_mul_f32 v137, s7, v137
    v_mul_f32 v138, s7, v138
    v_mul_f32 v139, s7, v139
    v_mul_f32 v140, s7, v140
    v_mul_f32 v141, s7, v141
    v_mul_f32 v142, s7, v142
    v_mul_f32 v143, s7, v143
    v_mul_f32 v144, s7, v144
    v_mul_f32 v145, s7, v145
    v_mul_f32 v146, s7, v146
    v_mul_f32 v147, s7, v147
    v_mul_f32 v148, s7, v148
    v_mul_f32 v149, s7, v149
    v_mul_f32 v150, s7, v150
    v_mul_f32 v151, s7, v151
    v_cvt_pk_bf16_f32 v64, v136, v137
    v_cvt_pk_bf16_f32 v65, v138, v139
    v_cvt_pk_bf16_f32 v66, v140, v141
    v_cvt_pk_bf16_f32 v67, v142, v143
    v_cvt_pk_bf16_f32 v68, v144, v145
    v_cvt_pk_bf16_f32 v69, v146, v147
    v_cvt_pk_bf16_f32 v70, v148, v149
    v_cvt_pk_bf16_f32 v71, v150, v151
    v_add_u32 v14, 0x4000, v14
    buffer_store_dwordx4 v[64:67], v14, s[20:23], 0 offen
    buffer_store_dwordx4 v[68:71], v14, s[20:23], 0 offen offset:16
    s_endpgm
K1_PREP:
    s_sub_u32 s3, s2, 237
    s_load_dwordx4 s[8:11], s[0:1], 32
    s_load_dwordx4 s[12:15], s[0:1], 48
    v_and_b32 v1, 63, v0
    v_lshrrev_b32 v2, 5, v1
    v_and_b32 v3, 31, v0
    s_waitcnt lgkmcnt(0)
    s_mov_b32 s20, s4
    s_mov_b32 s21, s5
    s_mov_b32 s22, 2883584
    s_mov_b32 s23, 0x00020000
    s_cmp_ge_u32 s3, 9
    s_cbranch_scc1 K1_PREP2
    s_add_u32 s3, s3, 8
    s_mov_b32 s16, s8
    s_mov_b32 s17, s9
    s_mov_b32 s18, 139264
    s_mov_b32 s19, 0x00020000
    v_lshrrev_b32 v4, 6, v0
    v_lshl_add_u32 v4, v4, 5, v3
    v_lshlrev_b32 v4, 1, v4
    v_lshl_add_u32 v4, v2, 12, v4
    s_lshl_b32 s6, s3, 13
    buffer_load_ushort v8, v4, s[16:19], s6 offen offset:0
    buffer_load_ushort v9, v4, s[16:19], s6 offen offset:512
    buffer_load_ushort v10, v4, s[16:19], s6 offen offset:1024
    buffer_load_ushort v11, v4, s[16:19], s6 offen offset:1536
    buffer_load_ushort v12, v4, s[16:19], s6 offen offset:2048
    buffer_load_ushort v13, v4, s[16:19], s6 offen offset:2560
    buffer_load_ushort v14, v4, s[16:19], s6 offen offset:3072
    buffer_load_ushort v15, v4, s[16:19], s6 offen offset:3584
    s_mov_b32 s7, 0xbfb8aa3b
    v_lshlrev_b32 v5, 4, v0
    s_waitcnt vmcnt(0)
    v_lshlrev_b32 v8, 16, v8
    v_lshlrev_b32 v9, 16, v9
    v_lshlrev_b32 v10, 16, v10
    v_lshlrev_b32 v11, 16, v11
    v_lshlrev_b32 v12, 16, v12
    v_lshlrev_b32 v13, 16, v13
    v_lshlrev_b32 v14, 16, v14
    v_lshlrev_b32 v15, 16, v15
    v_mul_f32 v8, s7, v8
    v_mul_f32 v9, s7, v9
    v_mul_f32 v10, s7, v10
    v_mul_f32 v11, s7, v11
    v_mul_f32 v12, s7, v12
    v_mul_f32 v13, s7, v13
    v_mul_f32 v14, s7, v14
    v_mul_f32 v15, s7, v15
    v_cvt_pk_bf16_f32 v16, v8, v9
    v_cvt_pk_bf16_f32 v17, v10, v11
    v_cvt_pk_bf16_f32 v18, v12, v13
    v_cvt_pk_bf16_f32 v19, v14, v15
    buffer_store_dwordx4 v[16:19], v5, s[20:23], s6 offen
    s_endpgm
K1_PREP2:
    s_cmp_ge_u32 s3, 17
    s_cbranch_scc1 K1_PREP3
    s_mov_b32 s16, s12
    s_mov_b32 s17, s13
    s_mov_b32 s18, 65536
    s_mov_b32 s19, 0x00020000
    s_sub_u32 s3, s3, 9
    v_lshrrev_b32 v4, 8, v0
    s_lshl_b32 s6, s3, 1
    v_add_u32 v4, s6, v4
    v_bfe_u32 v5, v0, 6, 2
    v_bfe_u32 v6, v3, 2, 1
    v_lshlrev_b32 v6, 4, v6
    v_lshrrev_b32 v7, 3, v3
    v_lshl_add_u32 v6, v7, 2, v6
    v_and_b32 v7, 3, v3
    v_add_u32 v6, v6, v7
    v_lshl_add_u32 v6, v5, 5, v6
    v_lshlrev_b32 v6, 1, v6
    v_lshl_add_u32 v6, v4, 12, v6
    v_lshl_add_u32 v6, v2, 10, v6
    buffer_load_ushort v8, v6, s[16:19], 0 offen offset:0
    buffer_load_ushort v9, v6, s[16:19], 0 offen offset:256
    buffer_load_ushort v10, v6, s[16:19], 0 offen offset:512
    buffer_load_ushort v11, v6, s[16:19], 0 offen offset:768
    buffer_load_ushort v12, v6, s[16:19], 0 offen offset:2048
    buffer_load_ushort v13, v6, s[16:19], 0 offen offset:2304
    buffer_load_ushort v14, v6, s[16:19], 0 offen offset:2560
    buffer_load_ushort v15, v6, s[16:19], 0 offen offset:2816
    v_lshl_add_u32 v5, v5, 4, v4
    v_lshlrev_b32 v5, 10, v5
    v_lshl_add_u32 v5, v1, 4, v5
    s_mov_b32 s6, 139264
    s_waitcnt vmcnt(0)
    v_lshl_or_b32 v16, v9, 16, v8
    v_lshl_or_b32 v17, v11, 16, v10
    v_lshl_or_b32 v18, v13, 16, v12
    v_lshl_or_b32 v19, v15, 16, v14
    buffer_store_dwordx4 v[16:19], v5, s[20:23], s6 offen
    s_endpgm
K1_PREP3:
    s_mov_b32 s16, s10
    s_mov_b32 s17, s11
    s_mov_b32 s18, 512
    s_mov_b32 s19, 0x00020000
    s_mov_b32 s24, s14
    s_mov_b32 s25, s15
    s_mov_b32 s26, 256
    s_mov_b32 s27, 0x00020000
    v_lshlrev_b32 v4, 1, v0
    v_lshlrev_b32 v5, 2, v0
    buffer_load_ushort v8, v4, s[16:19], 0 offen
    buffer_load_ushort v9, v4, s[24:27], 0 offen
    v_lshrrev_b32 v6, 4, v0
    v_and_b32 v7, 15, v0
    v_lshlrev_b32 v7, 1, v7
    v_mov_b32 v10, 0
    v_mov_b32 v11, 0x3f80
    v_mov_b32 v12, 0x3f800000
    v_cmp_eq_u32 vcc, v6, v7
    s_nop 1
    v_cndmask_b32 v10, v10, v11, vcc
    v_add_u32 v7, 1, v7
    v_cmp_eq_u32 vcc, v6, v7
    s_nop 1
    v_cndmask_b32 v10, v10, v12, vcc
    s_mov_b32 s6, 206336
    buffer_store_dword v10, v5, s[20:23], s6 offen
    s_mov_b32 s7, 0xbfb8aa3b
    s_waitcnt vmcnt(1)
    v_lshlrev_b32 v8, 16, v8
    v_lshlrev_b32 v9, 16, v9
    v_mul_f32 v8, s7, v8
    v_cmp_gt_u32 vcc, 256, v0
    s_and_saveexec_b64 s[28:29], vcc
    s_cbranch_execz K1_EXIT
    s_mov_b32 s6, 204800
    buffer_store_dword v8, v5, s[20:23], s6 offen
    v_cmp_gt_u32 vcc, 128, v0
    s_and_saveexec_b64 s[28:29], vcc
    s_cbranch_execz K1_EXIT
    s_mov_b32 s6, 205824
    buffer_store_dword v9, v5, s[20:23], s6 offen
K1_EXIT:
    s_endpgm
.globl k2_main_kernel
.p2align 8
.type k2_main_kernel,@function
k2_main_kernel:
    s_cmp_ge_u32 s2, 512
    s_cbranch_scc1 K2_EXIT
    s_load_dwordx2 s[28:29], s[0:1], 80
    s_load_dwordx4 s[4:7], s[0:1], 0
    s_load_dwordx2 s[24:25], s[0:1], 64
    v_lshrrev_b32 v248, 6, v0
    v_and_b32 v249, 63, v0
    v_readfirstlane_b32 s32, v248
    s_mov_b32 s33, s2
    s_lshr_b32 s42, s2, 8
    s_xor_b32 s33, s2, s42
    v_lshlrev_b32 v212, 4, v0
    v_lshlrev_b32 v213, 2, v0
    v_mov_b32 v221, v249
    s_mul_i32 s42, s33, 5120
    s_add_u32 s42, s42, 262144
    s_add_u32 s43, s42, 4096
    s_waitcnt lgkmcnt(0)
    s_mov_b32 s16, s28
    s_mov_b32 s17, s29
    s_mov_b32 s18, 8134656
    s_mov_b32 s19, 0x00020000
    buffer_load_dwordx4 v[248:251], v212, s[16:19], s42 offen
    buffer_load_dword v252, v213, s[16:19], s43 offen
    s_mul_i32 s34, s33, 625
    s_add_u32 s35, s34, 656
    s_add_u32 s34, s34, 31
    s_lshr_b32 s34, s34, 5
    s_lshr_b32 s35, s35, 5
    s_sub_u32 s35, s35, s34
    v_lshrrev_b32 v218, 4, v221
    v_and_b32 v220, 15, v221
    v_xor_b32 v220, v220, v218
    v_lshlrev_b32 v3, 4, v220
    v_mov_b32 v5, v3
    s_lshl_b32 s42, s32, 3
    v_add_u32 v220, s42, v218
    v_and_b32 v219, 8, v220
    v_lshrrev_b32 v219, 1, v219
    v_and_b32 v220, 0x13, v220
    v_or_b32 v220, v220, v219
    v_add_u32 v219, 8, v220
    v_mov_b32 v216, 0xffffff
    v_cmp_gt_u32 vcc, s35, v220
    v_add_u32 v220, s34, v220
    s_nop 0
    v_cndmask_b32 v2, v216, v220, vcc
    v_cmp_gt_u32 vcc, s35, v219
    v_add_u32 v219, s34, v219
    s_nop 0
    v_cndmask_b32 v4, v216, v219, vcc
    s_mov_b32 s8, s4
    s_or_b32 s9, s5, 0x1000000
    s_mov_b32 s10, 10000
    s_mov_b32 s11, 0x00020000
    s_mul_i32 s42, s32, 2176
    s_add_u32 m0, s42, 52480
    buffer_load_dwordx4 v[2:3], s[8:11], 0 idxen offen lds
    s_add_u32 m0, s42, 53568
    s_nop 0
    buffer_load_dwordx4 v[4:5], s[8:11], 0 idxen offen lds
    v_mov_b32 v208, 0xffffff
    v_mov_b32 v209, 0xffffff
    v_mov_b32 v210, 0xffffff
    v_mov_b32 v211, 0xffffff
    v_mov_b32 v236, 19520
    v_mov_b32 v237, 19520
    v_mov_b32 v238, 19520
    v_mov_b32 v239, 19520
    ds_write_b128 v212, v[208:211] offset:1024
    ds_write_b128 v212, v[208:211] offset:5120
    ds_write_b128 v212, v[236:239] offset:12288
    v_cmp_gt_u32 vcc, 3072, v212
    s_and_saveexec_b64 s[42:43], vcc
    ds_write_b128 v212, v[208:211] offset:9216
    s_mov_b64 exec, s[42:43]
    v_cmp_gt_u32 vcc, 1536, v212
    s_and_saveexec_b64 s[42:43], vcc
    ds_write_b128 v212, v[236:239] offset:16384
    s_mov_b64 exec, s[42:43]
    v_mov_b32 v214, 0
    ds_write_b32 v213, v214
    s_cmp_lg_u32 s32, 0
    s_cbranch_scc1 K2_NOTBL
    v_mov_b32 v236, 0
    v_mov_b32 v237, 0
    v_mov_b32 v238, 0
    v_mov_b32 v239, 0
    ds_write_b128 v212, v[236:239] offset:17920
    v_cmp_gt_u32 vcc, 768, v212
    s_and_saveexec_b64 s[42:43], vcc
    ds_write_b128 v212, v[236:239] offset:18944
    s_mov_b64 exec, s[42:43]
    v_cmp_gt_u32 vcc, 20, v221
    s_and_saveexec_b64 s[42:43], vcc
    v_mul_u32_u24 v236, 82, v221
    v_mov_b32 v237, 0x3f80
    ds_write_b16 v236, v237 offset:17920
    s_mov_b64 exec, s[42:43]
K2_NOTBL:
    v_and_b32 v216, 31, v221
    v_lshrrev_b32 v217, 5, v221
    v_lshrrev_b32 v218, 2, v216
    s_movk_i32 s42, 1088
    v_mul_u32_u24 v219, s42, v218
    v_and_b32 v220, 3, v216
    v_lshl_add_u32 v219, v220, 8, v219
    v_xor_b32 v220, v220, v217
    v_lshl_add_u32 v219, v220, 4, v219
    v_add_u32 v22, 52480, v219
    v_xor_b32 v23, 32, v22
    v_lshlrev_b32 v16, 4, v217
    v_bfe_u32 v220, v221, 4, 1
    v_lshlrev_b32 v220, 5, v220
    v_and_b32 v219, 3, v221
    v_lshl_add_u32 v20, v219, 3, v220
    v_bfe_u32 v219, v221, 2, 2
    v_lshl_add_u32 v219, v217, 2, v219
    v_lshlrev_b32 v219, 2, v219
    v_add_u32 v245, 12288, v219
    s_lshl_b32 s42, s32, 12
    s_add_u32 s39, s42, 19712
    v_bfe_u32 v220, v216, 1, 3
    v_xor_b32 v220, v220, v217
    v_lshlrev_b32 v220, 4, v220
    v_lshl_add_u32 v220, v216, 7, v220
    v_add_u32 v12, s39, v220
    v_xor_b32 v13, 32, v12
    v_xor_b32 v14, 64, v12
    v_xor_b32 v15, 96, v12
    v_and_b32 v220, 7, v221
    v_lshrrev_b32 v219, 4, v221
    v_xor_b32 v220, v220, v219
    v_lshlrev_b32 v220, 4, v220
    s_lshl_b32 s42, s32, 7
    v_add_u32 v244, s42, v220
    v_lshrrev_b32 v220, 3, v221
    v_lshlrev_b32 v220, 2, v220
    v_add_u32 v246, 1024, v220
    v_lshlrev_b32 v220, 3, v217
    v_sub_u32 v220, v216, v220
    v_and_b32 v219, 1, v220
    v_lshlrev_b32 v219, 4, v219
    v_mov_b32 v218, 0x3f80
    v_lshlrev_b32 v219, v219, v218
    v_ashrrev_i32 v220, 1, v220
    v_cmp_eq_u32 vcc, 0, v220
    s_nop 1
    v_cndmask_b32 v48, 0, v219, vcc
    v_cmp_eq_u32 vcc, 1, v220
    s_nop 1
    v_cndmask_b32 v49, 0, v219, vcc
    v_cmp_eq_u32 vcc, 2, v220
    s_nop 1
    v_cndmask_b32 v50, 0, v219, vcc
    v_cmp_eq_u32 vcc, 3, v220
    s_nop 1
    v_cndmask_b32 v51, 0, v219, vcc
    v_cmp_eq_u32 vcc, 8, v220
    s_nop 1
    v_cndmask_b32 v52, 0, v219, vcc
    v_cmp_eq_u32 vcc, 9, v220
    s_nop 1
    v_cndmask_b32 v53, 0, v219, vcc
    v_cmp_eq_u32 vcc, 10, v220
    s_nop 1
    v_cndmask_b32 v54, 0, v219, vcc
    v_cmp_eq_u32 vcc, 11, v220
    s_nop 1
    v_cndmask_b32 v55, 0, v219, vcc
    v_cmp_eq_u32 vcc, 0, v217
    s_nop 1
    v_cndmask_b32 v56, 0, v218, vcc
    v_mov_b32 v57, 0
    v_mov_b32 v58, 0
    v_mov_b32 v59, 0
    s_mov_b32 s20, s24
    s_mov_b32 s21, s25
    s_mov_b32 s22, 2560000
    s_mov_b32 s23, 0x00020000
    s_add_u32 s84, s28, 2883584
    s_addc_u32 s85, s29, 0
    s_or_b32 s85, s85, 0x2000000
    s_mov_b32 s86, 10000
    s_mov_b32 s87, 0x00020000
    s_mov_b32 s12, s6
    s_or_b32 s13, s7, 0x200000
    s_mov_b32 s14, 160000
    s_mov_b32 s15, 0x00020000
    v_lshlrev_b32 v11, 4, v217
    v_lshlrev_b32 v220, 2, v216
    v_add_u32 v247, 6656, v220
    s_movk_i32 s42, 2000
    v_lshrrev_b32 v224, 2, v0
    v_lshrrev_b32 v225, 4, v0
    v_add_u32 v225, 64, v225
    v_lshlrev_b32 v226, 2, v224
    v_lshlrev_b32 v227, 2, v225
    v_mul_u32_u24 v224, s42, v224
    v_mul_u32_u24 v225, s42, v225
    s_lshl_b32 s42, s32, 11
    v_lshl_add_u32 v222, v221, 4, s42
    s_mov_b32 s42, 65536
    buffer_load_dwordx4 v[60:63], v222, s[16:19], s42 offen offset:0
    buffer_load_dwordx4 v[92:95], v222, s[16:19], s42 offen offset:1024
    s_mov_b32 s42, 73728
    buffer_load_dwordx4 v[64:67], v222, s[16:19], s42 offen offset:0
    buffer_load_dwordx4 v[96:99], v222, s[16:19], s42 offen offset:1024
    s_mov_b32 s42, 81920
    buffer_load_dwordx4 v[68:71], v222, s[16:19], s42 offen offset:0
    buffer_load_dwordx4 v[100:103], v222, s[16:19], s42 offen offset:1024
    s_mov_b32 s42, 90112
    buffer_load_dwordx4 v[72:75], v222, s[16:19], s42 offen offset:0
    buffer_load_dwordx4 v[104:107], v222, s[16:19], s42 offen offset:1024
    s_mov_b32 s42, 98304
    buffer_load_dwordx4 v[76:79], v222, s[16:19], s42 offen offset:0
    buffer_load_dwordx4 v[108:111], v222, s[16:19], s42 offen offset:1024
    s_mov_b32 s42, 106496
    buffer_load_dwordx4 v[80:83], v222, s[16:19], s42 offen offset:0
    buffer_load_dwordx4 v[112:115], v222, s[16:19], s42 offen offset:1024
    s_mov_b32 s42, 114688
    buffer_load_dwordx4 v[84:87], v222, s[16:19], s42 offen offset:0
    buffer_load_dwordx4 v[116:119], v222, s[16:19], s42 offen offset:1024
    s_mov_b32 s42, 122880
    buffer_load_dwordx4 v[88:91], v222, s[16:19], s42 offen offset:0
    buffer_load_dwordx4 v[120:123], v222, s[16:19], s42 offen offset:1024
    v_and_b32 v223, 31, v221
    s_lshl_b32 s42, s32, 8
    v_lshl_add_u32 v223, v223, 2, s42
    s_mov_b32 s42, 204800
    buffer_load_dword v253, v223, s[16:19], s42 offen
    buffer_load_dword v254, v223, s[16:19], s42 offen offset:128
    s_mov_b32 s42, 131072
    buffer_load_dwordx4 v[24:27], v222, s[16:19], s42 offen offset:0
    buffer_load_dwordx4 v[28:31], v222, s[16:19], s42 offen offset:1024
    s_waitcnt lgkmcnt(0)
    s_barrier
    s_waitcnt vmcnt(22)
    v_cmp_eq_u32 vcc, -2, v248
    s_and_saveexec_b64 s[42:43], vcc
    v_mov_b32 v228, 1
    ds_write_b32 v226, v228 offset:256
    s_mov_b64 exec, s[42:43]
    v_cmp_eq_u32 vcc, -2, v252
    s_and_saveexec_b64 s[42:43], vcc
    v_mov_b32 v228, 1
    ds_write_b32 v227, v228 offset:256
    s_mov_b64 exec, s[42:43]
    v_cmp_le_i32_e64 s[44:45], 0, v248
    v_cmp_le_i32_e64 s[46:47], 0, v249
    v_cmp_le_i32_e64 s[48:49], 0, v250
    v_cmp_le_i32_e64 s[50:51], 0, v251
    v_cmp_le_i32_e64 s[52:53], 0, v252
    s_nop 0
    s_bcnt1_i32_b64 s61, s[44:45]
    s_bcnt1_i32_b64 s62, s[46:47]
    s_add_u32 s61, s61, s62
    s_bcnt1_i32_b64 s62, s[48:49]
    s_add_u32 s61, s61, s62
    s_bcnt1_i32_b64 s62, s[50:51]
    s_add_u32 s61, s61, s62
    s_bcnt1_i32_b64 s62, s[52:53]
    s_add_u32 s61, s61, s62
    v_mov_b32 v230, s61
    v_mov_b32 v234, 128
    v_mov_b32 v233, 1
    s_mov_b64 exec, 1
    ds_add_rtn_u32 v231, v234, v230
    s_waitcnt lgkmcnt(0)
    s_mov_b64 exec, -1
    v_readfirstlane_b32 s61, v231
    v_mbcnt_lo_u32_b32 v229, s44, 0
    v_mbcnt_hi_u32_b32 v229, s45, v229
    v_and_b32 v230, 0x3fff, v248
    v_bfe_u32 v231, v248, 14, 5
    v_lshrrev_b32 v232, 19, v248
    v_add_u32 v232, v232, v224
    v_add_u32 v229, s61, v229
    v_lshlrev_b32 v229, 2, v229
    v_lshlrev_b32 v234, 2, v231
    v_mul_u32_u24 v231, 80, v231
    v_add_u32 v231, 17920, v231
    s_mov_b64 exec, s[44:45]
    ds_write_b32 v229, v230 offset:1024
    ds_write_b32 v229, v232 offset:6656
    ds_write_b32 v229, v231 offset:12288
    ds_add_u32 v234, v233 offset:0
    s_mov_b64 exec, -1
    s_bcnt1_i32_b64 s62, s[44:45]
    s_add_u32 s61, s61, s62
    v_mbcnt_lo_u32_b32 v229, s46, 0
    v_mbcnt_hi_u32_b32 v229, s47, v229
    v_and_b32 v230, 0x3fff, v249
    v_bfe_u32 v231, v249, 14, 5
    v_lshrrev_b32 v232, 19, v249
    v_add_u32 v232, v232, v224
    v_add_u32 v229, s61, v229
    v_lshlrev_b32 v229, 2, v229
    v_lshlrev_b32 v234, 2, v231
    v_mul_u32_u24 v231, 80, v231
    v_add_u32 v231, 17920, v231
    s_mov_b64 exec, s[46:47]
    ds_write_b32 v229, v230 offset:1024
    ds_write_b32 v229, v232 offset:6656
    ds_write_b32 v229, v231 offset:12288
    ds_add_u32 v234, v233 offset:0
    s_mov_b64 exec, -1
    s_bcnt1_i32_b64 s62, s[46:47]
    s_add_u32 s61, s61, s62
    v_mbcnt_lo_u32_b32 v229, s48, 0
    v_mbcnt_hi_u32_b32 v229, s49, v229
    v_and_b32 v230, 0x3fff, v250
    v_bfe_u32 v231, v250, 14, 5
    v_lshrrev_b32 v232, 19, v250
    v_add_u32 v232, v232, v224
    v_add_u32 v229, s61, v229
    v_lshlrev_b32 v229, 2, v229
    v_lshlrev_b32 v234, 2, v231
    v_mul_u32_u24 v231, 80, v231
    v_add_u32 v231, 17920, v231
    s_mov_b64 exec, s[48:49]
    ds_write_b32 v229, v230 offset:1024
    ds_write_b32 v229, v232 offset:6656
    ds_write_b32 v229, v231 offset:12288
    ds_add_u32 v234, v233 offset:0
    s_mov_b64 exec, -1
    s_bcnt1_i32_b64 s62, s[48:49]
    s_add_u32 s61, s61, s62
    v_mbcnt_lo_u32_b32 v229, s50, 0
    v_mbcnt_hi_u32_b32 v229, s51, v229
    v_and_b32 v230, 0x3fff, v251
    v_bfe_u32 v231, v251, 14, 5
    v_lshrrev_b32 v232, 19, v251
    v_add_u32 v232, v232, v224
    v_add_u32 v229, s61, v229
    v_lshlrev_b32 v229, 2, v229
    v_lshlrev_b32 v234, 2, v231
    v_mul_u32_u24 v231, 80, v231
    v_add_u32 v231, 17920, v231
    s_mov_b64 exec, s[50:51]
    ds_write_b32 v229, v230 offset:1024
    ds_write_b32 v229, v232 offset:6656
    ds_write_b32 v229, v231 offset:12288
    ds_add_u32 v234, v233 offset:0
    s_mov_b64 exec, -1
    s_bcnt1_i32_b64 s62, s[50:51]
    s_add_u32 s61, s61, s62
    v_mbcnt_lo_u32_b32 v229, s52, 0
    v_mbcnt_hi_u32_b32 v229, s53, v229
    v_and_b32 v230, 0x3fff, v252
    v_bfe_u32 v231, v252, 14, 5
    v_lshrrev_b32 v232, 19, v252
    v_add_u32 v232, v232, v225
    v_add_u32 v229, s61, v229
    v_lshlrev_b32 v229, 2, v229
    v_lshlrev_b32 v234, 2, v231
    v_mul_u32_u24 v231, 80, v231
    v_add_u32 v231, 17920, v231
    s_mov_b64 exec, s[52:53]
    ds_write_b32 v229, v230 offset:1024
    ds_write_b32 v229, v232 offset:6656
    ds_write_b32 v229, v231 offset:12288
    ds_add_u32 v234, v233 offset:0
    s_mov_b64 exec, -1
    s_waitcnt vmcnt(20) lgkmcnt(0)
    s_barrier
    v_mov_b32 v234, 128
    ds_read_b32 v230, v234
    v_and_b32 v231, 63, v0
    v_lshlrev_b32 v231, 2, v231
    ds_read_b32 v232, v231 offset:256
    ds_read_b32 v229, v231 offset:512
    v_mov_b32 v21, v246
    v_mov_b32 v1, v247
    v_mov_b32 v255, v245
    v_mov_b32 v3, v244
    v_mov_b32 v193, v244
    v_xor_b32 v5, 64, v244
    v_xor_b32 v195, 64, v244
    v_mov_b32 v7, v244
    v_mov_b32 v197, v244
    v_xor_b32 v9, 64, v244
    v_xor_b32 v199, 64, v244
    v_mov_b32 v201, v11
    ds_read_b32 v10, v247 offset:0
    ds_read_b32 v2, v246 offset:0
    ds_read_b32 v4, v246 offset:32
    ds_read_b32 v6, v246 offset:64
    ds_read_b32 v8, v246 offset:96
    ds_read_b32 v200, v247 offset:128
    ds_read_b32 v192, v246 offset:128
    ds_read_b32 v194, v246 offset:160
    ds_read_b32 v196, v246 offset:192
    ds_read_b32 v198, v246 offset:224
    s_add_u32 m0, s39, 0
    s_waitcnt lgkmcnt(5)
    buffer_load_dwordx4 v[2:3], s[84:87], 0 idxen offen lds
    s_add_u32 m0, s39, 1024
    s_nop 0
    buffer_load_dwordx4 v[4:5], s[84:87], 0 idxen offen lds
    s_add_u32 m0, s39, 2048
    s_nop 0
    buffer_load_dwordx4 v[6:7], s[84:87], 0 idxen offen lds
    s_add_u32 m0, s39, 3072
    s_nop 0
    buffer_load_dwordx4 v[8:9], s[84:87], 0 idxen offen lds
    buffer_load_dwordx4 v[132:135], v[10:11], s[12:15], 0 idxen offen
    v_readfirstlane_b32 s36, v230
    v_cmp_ne_u32_e64 s[56:57], 0, v232
    v_cmp_ne_u32_e64 s[42:43], 0, v229
    s_nop 0
    s_and_b32 s58, s42, 0xffff
    s_mov_b32 s59, 0
    s_mov_b32 s60, 0
    s_add_u32 s37, s36, 31
    s_lshr_b32 s37, s37, 5
    ds_read_b128 v[208:211], v22 offset:0
    ds_read_b128 v[212:215], v23 offset:0
    ds_read_b128 v[216:219], v22 offset:64
    ds_read_b128 v[220:223], v23 offset:64
    ds_read_b128 v[224:227], v22 offset:128
    ds_read_b128 v[228:231], v23 offset:128
    ds_read_b128 v[232:235], v22 offset:192
    ds_read_b128 v[236:239], v23 offset:192
    s_waitcnt vmcnt(7)
    v_mov_b32 v160, v253
    v_mov_b32 v161, v253
    v_mov_b32 v162, v253
    v_mov_b32 v163, v253
    v_mov_b32 v164, v253
    v_mov_b32 v165, v253
    v_mov_b32 v166, v253
    v_mov_b32 v167, v253
    v_mov_b32 v168, v253
    v_mov_b32 v169, v253
    v_mov_b32 v170, v253
    v_mov_b32 v171, v253
    v_mov_b32 v172, v253
    v_mov_b32 v173, v253
    v_mov_b32 v174, v253
    v_mov_b32 v175, v253
    v_mov_b32 v176, v254
    v_mov_b32 v177, v254
    v_mov_b32 v178, v254
    v_mov_b32 v179, v254
    v_mov_b32 v180, v254
    v_mov_b32 v181, v254
    v_mov_b32 v182, v254
    v_mov_b32 v183, v254
    v_mov_b32 v184, v254
    v_mov_b32 v185, v254
    v_mov_b32 v186, v254
    v_mov_b32 v187, v254
    v_mov_b32 v188, v254
    v_mov_b32 v189, v254
    v_mov_b32 v190, v254
    v_mov_b32 v191, v254
    s_waitcnt lgkmcnt(0)
    s_barrier
    v_mfma_f32_32x32x16_bf16 v[160:175], v[208:211], v[60:63], v[160:175]
    v_mfma_f32_32x32x16_bf16 v[176:191], v[208:211], v[92:95], v[176:191]
    v_mfma_f32_32x32x16_bf16 v[160:175], v[212:215], v[64:67], v[160:175]
    v_mfma_f32_32x32x16_bf16 v[176:191], v[212:215], v[96:99], v[176:191]
    v_mfma_f32_32x32x16_bf16 v[160:175], v[216:219], v[68:71], v[160:175]
    v_mfma_f32_32x32x16_bf16 v[176:191], v[216:219], v[100:103], v[176:191]
    v_mfma_f32_32x32x16_bf16 v[160:175], v[220:223], v[72:75], v[160:175]
    v_mfma_f32_32x32x16_bf16 v[176:191], v[220:223], v[104:107], v[176:191]
    s_add_u32 m0, s39, 16384
    s_nop 0
    buffer_load_dwordx4 v[192:193], s[84:87], 0 idxen offen lds
    s_add_u32 m0, s39, 17408
    s_nop 0
    buffer_load_dwordx4 v[194:195], s[84:87], 0 idxen offen lds
    s_add_u32 m0, s39, 18432
    s_nop 0
    buffer_load_dwordx4 v[196:197], s[84:87], 0 idxen offen lds
    s_add_u32 m0, s39, 19456
    s_nop 0
    buffer_load_dwordx4 v[198:199], s[84:87], 0 idxen offen lds
    buffer_load_dwordx4 v[240:243], v[200:201], s[12:15], 0 idxen offen
    v_mfma_f32_32x32x16_bf16 v[160:175], v[224:227], v[76:79], v[160:175]
    v_mfma_f32_32x32x16_bf16 v[176:191], v[224:227], v[108:111], v[176:191]
    v_mfma_f32_32x32x16_bf16 v[160:175], v[228:231], v[80:83], v[160:175]
    v_mfma_f32_32x32x16_bf16 v[176:191], v[228:231], v[112:115], v[176:191]
    v_mfma_f32_32x32x16_bf16 v[160:175], v[232:235], v[84:87], v[160:175]
    v_mfma_f32_32x32x16_bf16 v[176:191], v[232:235], v[116:119], v[176:191]
    v_mfma_f32_32x32x16_bf16 v[160:175], v[236:239], v[88:91], v[160:175]
    v_mfma_f32_32x32x16_bf16 v[176:191], v[236:239], v[120:123], v[176:191]
    s_nop 7
    s_nop 3
    v_cvt_pk_bf16_f32 v32, v160, v161
    v_cvt_pk_bf16_f32 v33, v162, v163
    v_cvt_pk_bf16_f32 v34, v164, v165
    v_cvt_pk_bf16_f32 v35, v166, v167
    v_cvt_pk_bf16_f32 v36, v168, v169
    v_cvt_pk_bf16_f32 v37, v170, v171
    v_cvt_pk_bf16_f32 v38, v172, v173
    v_cvt_pk_bf16_f32 v39, v174, v175
    v_cvt_pk_bf16_f32 v40, v176, v177
    v_cvt_pk_bf16_f32 v41, v178, v179
    v_cvt_pk_bf16_f32 v42, v180, v181
    v_cvt_pk_bf16_f32 v43, v182, v183
    v_cvt_pk_bf16_f32 v44, v184, v185
    v_cvt_pk_bf16_f32 v45, v186, v187
    v_cvt_pk_bf16_f32 v46, v188, v189
    v_cvt_pk_bf16_f32 v47, v190, v191
    v_mov_b32 v60, 0
    v_mov_b32 v61, 0
    v_mov_b32 v62, 0
    v_mov_b32 v63, 0
    v_mov_b32 v64, 0
    v_mov_b32 v65, 0
    v_mov_b32 v66, 0
    v_mov_b32 v67, 0
    v_mov_b32 v68, 0
    v_mov_b32 v69, 0
    v_mov_b32 v70, 0
    v_mov_b32 v71, 0
    v_mov_b32 v72, 0
    v_mov_b32 v73, 0
    v_mov_b32 v74, 0
    v_mov_b32 v75, 0
    v_mov_b32 v76, 0
    v_mov_b32 v77, 0
    v_mov_b32 v78, 0
    v_mov_b32 v79, 0
    v_mov_b32 v80, 0
    v_mov_b32 v81, 0
    v_mov_b32 v82, 0
    v_mov_b32 v83, 0
    v_mov_b32 v84, 0
    v_mov_b32 v85, 0
    v_mov_b32 v86, 0
    v_mov_b32 v87, 0
    v_mov_b32 v88, 0
    v_mov_b32 v89, 0
    v_mov_b32 v90, 0
    v_mov_b32 v91, 0
K2_PIPE:
    s_cmp_eq_u32 s37, 0
    s_cbranch_scc1 K2_AFTER
    v_mov_b32 v124, 0
    v_mov_b32 v125, 0
    v_mov_b32 v126, 0
    v_mov_b32 v127, 0
    v_mov_b32 v128, 0
    v_mov_b32 v129, 0
    v_mov_b32 v130, 0
    v_mov_b32 v131, 0
    v_mov_b32 v144, 0
    v_mov_b32 v145, 0
    v_mov_b32 v146, 0
    v_mov_b32 v147, 0
    v_mov_b32 v148, 0
    v_mov_b32 v149, 0
    v_mov_b32 v150, 0
    v_mov_b32 v151, 0
    s_waitcnt vmcnt(5)
    v_mov_b32 v209, v244
    v_xor_b32 v211, 64, v244
    v_mov_b32 v213, v244
    v_xor_b32 v215, 64, v244
    v_mov_b32 v217, v11
    ds_read_b32 v17, v1 offset:5632
    ds_read_b128 v[152:155], v12 offset:0
    ds_read_b128 v[156:159], v13 offset:0
    s_waitcnt lgkmcnt(2)
    v_add_u32 v17, v16, v17
    ds_read_b128 v[136:139], v17 offset:0
    ds_read_b128 v[140:143], v17 offset:32
    ds_read_b32 v216, v247 offset:256
    ds_read_b32 v208, v246 offset:256
    ds_read_b32 v210, v246 offset:288
    ds_read_b32 v212, v246 offset:320
    ds_read_b32 v214, v246 offset:352
    s_waitcnt lgkmcnt(8)
    v_mfma_f32_32x32x16_bf16 v[160:175], v[152:155], v[48:51], 0
    ds_read_b128 v[152:155], v14 offset:0
    s_add_u32 m0, s39, 32768
    s_nop 0
    s_waitcnt lgkmcnt(4)
    buffer_load_dwordx4 v[208:209], s[84:87], 0 idxen offen lds
    v_mfma_f32_32x32x16_bf16 v[160:175], v[156:159], v[52:55], v[160:175]
    ds_read_b128 v[156:159], v15 offset:0
    s_add_u32 m0, s39, 33792
    s_nop 0
    s_waitcnt lgkmcnt(4)
    buffer_load_dwordx4 v[210:211], s[84:87], 0 idxen offen lds
    v_mfma_f32_32x32x16_bf16 v[160:175], v[132:135], v[24:27], v[160:175]
    s_add_u32 m0, s39, 34816
    s_nop 0
    s_waitcnt lgkmcnt(3)
    buffer_load_dwordx4 v[212:213], s[84:87], 0 idxen offen lds
    v_mfma_f32_32x32x16_bf16 v[160:175], v[136:139], v[32:35], v[160:175]
    s_add_u32 m0, s39, 35840
    s_nop 0
    s_waitcnt lgkmcnt(2)
    buffer_load_dwordx4 v[214:215], s[84:87], 0 idxen offen lds
    v_mfma_f32_32x32x16_bf16 v[160:175], v[140:143], v[36:39], v[160:175]
    buffer_load_dwordx4 v[236:239], v[216:217], s[12:15], 0 idxen offen
    ds_read_b32 v10, v1 offset:384
    ds_read_b32 v2, v21 offset:384
    ds_read_b32 v4, v21 offset:416
    ds_read_b32 v6, v21 offset:448
    ds_read_b32 v8, v21 offset:480
    ds_read_b32 v17, v1 offset:5760
    s_nop 7
    s_nop 4
    v_exp_f32 v92, v160
    v_exp_f32 v93, v161
    v_exp_f32 v94, v162
    v_exp_f32 v95, v163
    s_waitcnt lgkmcnt(0)
    v_add_u32 v17, v16, v17
    v_exp_f32 v96, v164
    v_exp_f32 v97, v165
    v_exp_f32 v98, v166
    s_waitcnt vmcnt(5)
    v_mfma_f32_32x32x16_bf16 v[176:191], v[152:155], v[48:51], 0
    ds_read_b128 v[152:155], v12 offset:16384
    v_exp_f32 v99, v167
    v_exp_f32 v100, v168
    ds_read2_b32 v[18:19], v255 offset0:0 offset1:8
    ds_read2_b32 v[22:23], v255 offset0:16 offset1:24
    v_exp_f32 v101, v169
    v_exp_f32 v102, v170
    v_exp_f32 v103, v171
    v_mfma_f32_32x32x16_bf16 v[176:191], v[156:159], v[52:55], v[176:191]
    ds_read_b128 v[156:159], v13 offset:16384
    v_exp_f32 v104, v172
    v_exp_f32 v105, v173
    v_exp_f32 v106, v174
    v_exp_f32 v107, v175
    v_mfma_f32_32x32x16_bf16 v[176:191], v[132:135], v[28:31], v[176:191]
    v_mfma_f32_32x32x16_bf16 v[176:191], v[136:139], v[40:43], v[176:191]
    ds_read_b128 v[136:139], v17 offset:0
    v_mfma_f32_32x32x16_bf16 v[176:191], v[140:143], v[44:47], v[176:191]
    ds_read_b128 v[140:143], v17 offset:32
    s_nop 0
    s_waitcnt lgkmcnt(4)
    v_add_u32 v18, v20, v18
    v_add_u32 v19, v20, v19
    s_waitcnt lgkmcnt(3)
    v_add_u32 v22, v20, v22
    v_add_u32 v23, v20, v23
    s_add_u32 m0, s39, 0
    s_nop 0
    buffer_load_dwordx4 v[2:3], s[84:87], 0 idxen offen lds
    s_add_u32 m0, s39, 1024
    s_nop 0
    buffer_load_dwordx4 v[4:5], s[84:87], 0 idxen offen lds
    s_add_u32 m0, s39, 2048
    s_nop 0
    buffer_load_dwordx4 v[6:7], s[84:87], 0 idxen offen lds
    s_add_u32 m0, s39, 3072
    s_nop 0
    buffer_load_dwordx4 v[8:9], s[84:87], 0 idxen offen lds
    buffer_load_dwordx4 v[132:135], v[10:11], s[12:15], 0 idxen offen
    s_nop 1
    v_mfma_f32_32x32x16_bf16 v[92:107], v[56:59], v[56:59], v[92:107]
    s_waitcnt lgkmcnt(0)
    s_mov_b32 s38, s37
    s_setprio 3
K2_LOOP:
    s_cmp_eq_u32 s38, 1
    s_cbranch_scc1 K2_TAIL0
    s_cmp_eq_u32 s38, 5
    s_cbranch_scc1 K2_PR0_2
K2_PRB0_2:
    s_cmp_eq_u32 s38, 2
    s_cbranch_scc1 K2_PR0_1
K2_PRB0_1:
    v_exp_f32 v108, v176
    v_exp_f32 v109, v177
    v_mfma_f32_32x32x16_bf16 v[76:91], v[128:131], v[148:151], v[76:91]
    ds_read_b64_tr_b16 v[144:145], v18
    ds_read_b64_tr_b16 v[146:147], v19
    ds_read_b64_tr_b16 v[148:149], v22
    ds_read_b64_tr_b16 v[150:151], v23
    v_exp_f32 v110, v178
    v_exp_f32 v111, v179
    v_exp_f32 v112, v180
    v_exp_f32 v113, v181
    v_exp_f32 v114, v182
    v_mfma_f32_32x32x16_bf16 v[192:207], v[152:155], v[48:51], 0
    ds_read_b128 v[152:155], v14 offset:16384
    v_exp_f32 v115, v183
    v_exp_f32 v116, v184
    v_exp_f32 v117, v185
    v_exp_f32 v118, v186
    v_exp_f32 v119, v187
    s_waitcnt lgkmcnt(7)
    v_mfma_f32_32x32x16_bf16 v[192:207], v[156:159], v[52:55], v[192:207]
    ds_read_b128 v[156:159], v15 offset:16384
    v_exp_f32 v120, v188
    v_exp_f32 v121, v189
    v_exp_f32 v122, v190
    v_exp_f32 v123, v191
    v_rcp_f32 v92, v92
    v_rcp_f32 v93, v93
    v_mfma_f32_32x32x16_bf16 v[108:123], v[56:59], v[56:59], v[108:123]
    v_rcp_f32 v94, v94
    v_rcp_f32 v95, v95
    v_rcp_f32 v96, v96
    v_rcp_f32 v97, v97
    v_rcp_f32 v98, v98
    v_mfma_f32_32x32x16_bf16 v[192:207], v[240:243], v[24:27], v[192:207]
    v_rcp_f32 v99, v99
    v_mul_f32 v92, v160, v92
    v_mul_f32 v93, v161, v93
    v_mul_f32 v94, v162, v94
    v_mul_f32 v95, v163, v95
    v_rcp_f32 v100, v100
    s_waitcnt lgkmcnt(7)
    v_mfma_f32_32x32x16_bf16 v[192:207], v[136:139], v[32:35], v[192:207]
    v_rcp_f32 v101, v101
    v_rcp_f32 v102, v102
    v_rcp_f32 v103, v103
    v_mul_f32 v96, v164, v96
    v_mul_f32 v97, v165, v97
    v_mul_f32 v98, v166, v98
    v_mul_f32 v99, v167, v99
    s_waitcnt lgkmcnt(6)
    v_mfma_f32_32x32x16_bf16 v[192:207], v[140:143], v[36:39], v[192:207]
    v_cvt_pk_bf16_f32 v124, v92, v93
    v_cvt_pk_bf16_f32 v125, v94, v95
    v_rcp_f32 v104, v104
    v_rcp_f32 v105, v105
    ds_read_b32 v10, v1 offset:512
    ds_read_b32 v2, v21 offset:512
    ds_read_b32 v4, v21 offset:544
    ds_read_b32 v6, v21 offset:576
    ds_read_b32 v8, v21 offset:608
    ds_read_b32 v17, v1 offset:5888
    v_rcp_f32 v106, v106
    v_rcp_f32 v107, v107
    v_mul_f32 v100, v168, v100
    v_mul_f32 v101, v169, v101
    v_mul_f32 v102, v170, v102
    v_mul_f32 v103, v171, v103
    v_cvt_pk_bf16_f32 v126, v96, v97
    v_cvt_pk_bf16_f32 v127, v98, v99
    v_mul_f32 v104, v172, v104
    v_mul_f32 v105, v173, v105
    s_waitcnt lgkmcnt(10)
    v_mfma_f32_32x32x16_bf16 v[60:75], v[124:127], v[144:147], v[60:75]
    v_mul_f32 v106, v174, v106
    v_mul_f32 v107, v175, v107
    v_cvt_pk_bf16_f32 v128, v100, v101
    v_cvt_pk_bf16_f32 v129, v102, v103
    v_cvt_pk_bf16_f32 v130, v104, v105
    v_cvt_pk_bf16_f32 v131, v106, v107
    v_exp_f32 v92, v192
    v_exp_f32 v93, v193
    s_waitcnt lgkmcnt(8)
    v_mfma_f32_32x32x16_bf16 v[60:75], v[128:131], v[148:151], v[60:75]
    v_exp_f32 v94, v194
    v_exp_f32 v95, v195
    s_waitcnt lgkmcnt(0)
    v_add_u32 v17, v16, v17
    v_exp_f32 v96, v196
    v_exp_f32 v97, v197
    v_exp_f32 v98, v198
    s_waitcnt vmcnt(5)
    v_mfma_f32_32x32x16_bf16 v[160:175], v[152:155], v[48:51], 0
    ds_read_b128 v[152:155], v12 offset:32768
    v_exp_f32 v99, v199
    v_exp_f32 v100, v200
    ds_read2_b32 v[18:19], v255 offset0:32 offset1:40
    ds_read2_b32 v[22:23], v255 offset0:48 offset1:56
    v_exp_f32 v101, v201
    v_exp_f32 v102, v202
    v_exp_f32 v103, v203
    v_mfma_f32_32x32x16_bf16 v[160:175], v[156:159], v[52:55], v[160:175]
    ds_read_b128 v[156:159], v13 offset:32768
    v_exp_f32 v104, v204
    v_exp_f32 v105, v205
    s_add_u32 m0, s39, 16384
    v_exp_f32 v106, v206
    buffer_load_dwordx4 v[2:3], s[84:87], 0 idxen offen lds
    v_exp_f32 v107, v207
    v_rcp_f32 v108, v108
    v_rcp_f32 v109, v109
    v_mfma_f32_32x32x16_bf16 v[92:107], v[56:59], v[56:59], v[92:107]
    v_rcp_f32 v110, v110
    v_rcp_f32 v111, v111
    s_add_u32 m0, s39, 17408
    v_rcp_f32 v112, v112
    buffer_load_dwordx4 v[4:5], s[84:87], 0 idxen offen lds
    v_rcp_f32 v113, v113
    v_rcp_f32 v114, v114
    v_mfma_f32_32x32x16_bf16 v[160:175], v[240:243], v[28:31], v[160:175]
    v_rcp_f32 v115, v115
    v_mul_f32 v108, v176, v108
    v_mul_f32 v109, v177, v109
    s_add_u32 m0, s39, 18432
    v_mul_f32 v110, v178, v110
    buffer_load_dwordx4 v[6:7], s[84:87], 0 idxen offen lds
    v_mul_f32 v111, v179, v111
    v_rcp_f32 v116, v116
    v_mfma_f32_32x32x16_bf16 v[160:175], v[136:139], v[40:43], v[160:175]
    ds_read_b128 v[136:139], v17 offset:0
    v_rcp_f32 v117, v117
    v_rcp_f32 v118, v118
    v_rcp_f32 v119, v119
    v_mul_f32 v112, v180, v112
    s_add_u32 m0, s39, 19456
    v_mul_f32 v113, v181, v113
    buffer_load_dwordx4 v[8:9], s[84:87], 0 idxen offen lds
    v_mul_f32 v114, v182, v114
    v_mul_f32 v115, v183, v115
    v_mfma_f32_32x32x16_bf16 v[160:175], v[140:143], v[44:47], v[160:175]
    ds_read_b128 v[140:143], v17 offset:32
    v_cvt_pk_bf16_f32 v124, v108, v109
    v_cvt_pk_bf16_f32 v125, v110, v111
    v_rcp_f32 v120, v120
    v_rcp_f32 v121, v121
    v_rcp_f32 v122, v122
    buffer_load_dwordx4 v[240:243], v[10:11], s[12:15], 0 idxen offen
    v_rcp_f32 v123, v123
    v_mul_f32 v116, v184, v116
    v_mul_f32 v117, v185, v117
    v_mul_f32 v118, v186, v118
    v_mul_f32 v119, v187, v119
    v_cvt_pk_bf16_f32 v126, v112, v113
    v_cvt_pk_bf16_f32 v127, v114, v115
    v_mul_f32 v120, v188, v120
    v_mul_f32 v121, v189, v121
    v_mfma_f32_32x32x16_bf16 v[76:91], v[124:127], v[144:147], v[76:91]
    v_mul_f32 v122, v190, v122
    v_mul_f32 v123, v191, v123
    s_waitcnt lgkmcnt(4)
    v_add_u32 v18, v20, v18
    v_add_u32 v19, v20, v19
    s_waitcnt lgkmcnt(3)
    v_add_u32 v22, v20, v22
    v_add_u32 v23, v20, v23
    v_cvt_pk_bf16_f32 v128, v116, v117
    v_cvt_pk_bf16_f32 v129, v118, v119
    v_cvt_pk_bf16_f32 v130, v120, v121
    v_cvt_pk_bf16_f32 v131, v122, v123
    s_sub_u32 s38, s38, 1
    s_cmp_eq_u32 s38, 1
    s_cbranch_scc1 K2_TAIL1
    s_cmp_eq_u32 s38, 5
    s_cbranch_scc1 K2_PR1_2
K2_PRB1_2:
    s_cmp_eq_u32 s38, 2
    s_cbranch_scc1 K2_PR1_1
K2_PRB1_1:
    v_exp_f32 v108, v160
    v_exp_f32 v109, v161
    v_mfma_f32_32x32x16_bf16 v[76:91], v[128:131], v[148:151], v[76:91]
    ds_read_b64_tr_b16 v[144:145], v18
    ds_read_b64_tr_b16 v[146:147], v19
    ds_read_b64_tr_b16 v[148:149], v22
    ds_read_b64_tr_b16 v[150:151], v23
    v_exp_f32 v110, v162
    v_exp_f32 v111, v163
    v_exp_f32 v112, v164
    v_exp_f32 v113, v165
    v_exp_f32 v114, v166
    v_mfma_f32_32x32x16_bf16 v[176:191], v[152:155], v[48:51], 0
    ds_read_b128 v[152:155], v14 offset:32768
    v_exp_f32 v115, v167
    v_exp_f32 v116, v168
    v_exp_f32 v117, v169
    v_exp_f32 v118, v170
    v_exp_f32 v119, v171
    s_waitcnt lgkmcnt(7)
    v_mfma_f32_32x32x16_bf16 v[176:191], v[156:159], v[52:55], v[176:191]
    ds_read_b128 v[156:159], v15 offset:32768
    v_exp_f32 v120, v172
    v_exp_f32 v121, v173
    v_exp_f32 v122, v174
    v_exp_f32 v123, v175
    v_rcp_f32 v92, v92
    v_rcp_f32 v93, v93
    v_mfma_f32_32x32x16_bf16 v[108:123], v[56:59], v[56:59], v[108:123]
    v_rcp_f32 v94, v94
    v_rcp_f32 v95, v95
    v_rcp_f32 v96, v96
    v_rcp_f32 v97, v97
    v_rcp_f32 v98, v98
    v_mfma_f32_32x32x16_bf16 v[176:191], v[236:239], v[24:27], v[176:191]
    v_rcp_f32 v99, v99
    v_mul_f32 v92, v192, v92
    v_mul_f32 v93, v193, v93
    v_mul_f32 v94, v194, v94
    v_mul_f32 v95, v195, v95
    v_rcp_f32 v100, v100
    s_waitcnt lgkmcnt(7)
    v_mfma_f32_32x32x16_bf16 v[176:191], v[136:139], v[32:35], v[176:191]
    v_rcp_f32 v101, v101
    v_rcp_f32 v102, v102
    v_rcp_f32 v103, v103
    v_mul_f32 v96, v196, v96
    v_mul_f32 v97, v197, v97
    v_mul_f32 v98, v198, v98
    v_mul_f32 v99, v199, v99
    s_waitcnt lgkmcnt(6)
    v_mfma_f32_32x32x16_bf16 v[176:191], v[140:143], v[36:39], v[176:191]
    v_cvt_pk_bf16_f32 v124, v92, v93
    v_cvt_pk_bf16_f32 v125, v94, v95
    v_rcp_f32 v104, v104
    v_rcp_f32 v105, v105
    ds_read_b32 v10, v1 offset:640
    ds_read_b32 v2, v21 offset:640
    ds_read_b32 v4, v21 offset:672
    ds_read_b32 v6, v21 offset:704
    ds_read_b32 v8, v21 offset:736
    ds_read_b32 v17, v1 offset:6016
    v_rcp_f32 v106, v106
    v_rcp_f32 v107, v107
    v_mul_f32 v100, v200, v100
    v_mul_f32 v101, v201, v101
    v_mul_f32 v102, v202, v102
    v_mul_f32 v103, v203, v103
    v_cvt_pk_bf16_f32 v126, v96, v97
    v_cvt_pk_bf16_f32 v127, v98, v99
    v_mul_f32 v104, v204, v104
    v_mul_f32 v105, v205, v105
    s_waitcnt lgkmcnt(10)
    v_mfma_f32_32x32x16_bf16 v[60:75], v[124:127], v[144:147], v[60:75]
    v_mul_f32 v106, v206, v106
    v_mul_f32 v107, v207, v107
    v_cvt_pk_bf16_f32 v128, v100, v101
    v_cvt_pk_bf16_f32 v129, v102, v103
    v_cvt_pk_bf16_f32 v130, v104, v105
    v_cvt_pk_bf16_f32 v131, v106, v107
    v_exp_f32 v92, v176
    v_exp_f32 v93, v177
    s_waitcnt lgkmcnt(8)
    v_mfma_f32_32x32x16_bf16 v[60:75], v[128:131], v[148:151], v[60:75]
    v_exp_f32 v94, v178
    v_exp_f32 v95, v179
    s_waitcnt lgkmcnt(0)
    v_add_u32 v17, v16, v17
    v_exp_f32 v96, v180
    v_exp_f32 v97, v181
    v_exp_f32 v98, v182
    s_waitcnt vmcnt(5)
    v_mfma_f32_32x32x16_bf16 v[192:207], v[152:155], v[48:51], 0
    ds_read_b128 v[152:155], v12 offset:0
    v_exp_f32 v99, v183
    v_exp_f32 v100, v184
    ds_read2_b32 v[18:19], v255 offset0:64 offset1:72
    ds_read2_b32 v[22:23], v255 offset0:80 offset1:88
    v_exp_f32 v101, v185
    v_exp_f32 v102, v186
    v_exp_f32 v103, v187
    v_mfma_f32_32x32x16_bf16 v[192:207], v[156:159], v[52:55], v[192:207]
    ds_read_b128 v[156:159], v13 offset:0
    v_exp_f32 v104, v188
    v_exp_f32 v105, v189
    s_add_u32 m0, s39, 32768
    v_exp_f32 v106, v190
    buffer_load_dwordx4 v[2:3], s[84:87], 0 idxen offen lds
    v_exp_f32 v107, v191
    v_rcp_f32 v108, v108
    v_rcp_f32 v109, v109
    v_mfma_f32_32x32x16_bf16 v[92:107], v[56:59], v[56:59], v[92:107]
    v_rcp_f32 v110, v110
    v_rcp_f32 v111, v111
    s_add_u32 m0, s39, 33792
    v_rcp_f32 v112, v112
    buffer_load_dwordx4 v[4:5], s[84:87], 0 idxen offen lds
    v_rcp_f32 v113, v113
    v_rcp_f32 v114, v114
    v_mfma_f32_32x32x16_bf16 v[192:207], v[236:239], v[28:31], v[192:207]
    v_rcp_f32 v115, v115
    v_mul_f32 v108, v160, v108
    v_mul_f32 v109, v161, v109
    s_add_u32 m0, s39, 34816
    v_mul_f32 v110, v162, v110
    buffer_load_dwordx4 v[6:7], s[84:87], 0 idxen offen lds
    v_mul_f32 v111, v163, v111
    v_rcp_f32 v116, v116
    v_mfma_f32_32x32x16_bf16 v[192:207], v[136:139], v[40:43], v[192:207]
    ds_read_b128 v[136:139], v17 offset:0
    v_rcp_f32 v117, v117
    v_rcp_f32 v118, v118
    v_rcp_f32 v119, v119
    v_mul_f32 v112, v164, v112
    s_add_u32 m0, s39, 35840
    v_mul_f32 v113, v165, v113
    buffer_load_dwordx4 v[8:9], s[84:87], 0 idxen offen lds
    v_mul_f32 v114, v166, v114
    v_mul_f32 v115, v167, v115
    v_mfma_f32_32x32x16_bf16 v[192:207], v[140:143], v[44:47], v[192:207]
    ds_read_b128 v[140:143], v17 offset:32
    v_cvt_pk_bf16_f32 v124, v108, v109
    v_cvt_pk_bf16_f32 v125, v110, v111
    v_rcp_f32 v120, v120
    v_rcp_f32 v121, v121
    v_rcp_f32 v122, v122
    buffer_load_dwordx4 v[236:239], v[10:11], s[12:15], 0 idxen offen
    v_rcp_f32 v123, v123
    v_mul_f32 v116, v168, v116
    v_mul_f32 v117, v169, v117
    v_mul_f32 v118, v170, v118
    v_mul_f32 v119, v171, v119
    v_cvt_pk_bf16_f32 v126, v112, v113
    v_cvt_pk_bf16_f32 v127, v114, v115
    v_mul_f32 v120, v172, v120
    v_mul_f32 v121, v173, v121
    v_mfma_f32_32x32x16_bf16 v[76:91], v[124:127], v[144:147], v[76:91]
    v_mul_f32 v122, v174, v122
    v_mul_f32 v123, v175, v123
    s_waitcnt lgkmcnt(4)
    v_add_u32 v18, v20, v18
    v_add_u32 v19, v20, v19
    s_waitcnt lgkmcnt(3)
    v_add_u32 v22, v20, v22
    v_add_u32 v23, v20, v23
    v_cvt_pk_bf16_f32 v128, v116, v117
    v_cvt_pk_bf16_f32 v129, v118, v119
    v_cvt_pk_bf16_f32 v130, v120, v121
    v_cvt_pk_bf16_f32 v131, v122, v123
    s_sub_u32 s38, s38, 1
    s_cmp_eq_u32 s38, 1
    s_cbranch_scc1 K2_TAIL2
    s_cmp_eq_u32 s38, 5
    s_cbranch_scc1 K2_PR2_2
K2_PRB2_2:
    s_cmp_eq_u32 s38, 2
    s_cbranch_scc1 K2_PR2_1
K2_PRB2_1:
    v_exp_f32 v108, v192
    v_exp_f32 v109, v193
    v_mfma_f32_32x32x16_bf16 v[76:91], v[128:131], v[148:151], v[76:91]
    ds_read_b64_tr_b16 v[144:145], v18
    ds_read_b64_tr_b16 v[146:147], v19
    ds_read_b64_tr_b16 v[148:149], v22
    ds_read_b64_tr_b16 v[150:151], v23
    v_exp_f32 v110, v194
    v_exp_f32 v111, v195
    v_exp_f32 v112, v196
    v_exp_f32 v113, v197
    v_exp_f32 v114, v198
    v_mfma_f32_32x32x16_bf16 v[160:175], v[152:155], v[48:51], 0
    ds_read_b128 v[152:155], v14 offset:0
    v_exp_f32 v115, v199
    v_exp_f32 v116, v200
    v_exp_f32 v117, v201
    v_exp_f32 v118, v202
    v_exp_f32 v119, v203
    s_waitcnt lgkmcnt(7)
    v_mfma_f32_32x32x16_bf16 v[160:175], v[156:159], v[52:55], v[160:175]
    ds_read_b128 v[156:159], v15 offset:0
    v_exp_f32 v120, v204
    v_exp_f32 v121, v205
    v_exp_f32 v122, v206
    v_exp_f32 v123, v207
    v_rcp_f32 v92, v92
    v_rcp_f32 v93, v93
    v_mfma_f32_32x32x16_bf16 v[108:123], v[56:59], v[56:59], v[108:123]
    v_rcp_f32 v94, v94
    v_rcp_f32 v95, v95
    v_rcp_f32 v96, v96
    v_rcp_f32 v97, v97
    v_rcp_f32 v98, v98
    v_mfma_f32_32x32x16_bf16 v[160:175], v[132:135], v[24:27], v[160:175]
    v_rcp_f32 v99, v99
    v_mul_f32 v92, v176, v92
    v_mul_f32 v93, v177, v93
    v_mul_f32 v94, v178, v94
    v_mul_f32 v95, v179, v95
    v_rcp_f32 v100, v100
    s_waitcnt lgkmcnt(7)
    v_mfma_f32_32x32x16_bf16 v[160:175], v[136:139], v[32:35], v[160:175]
    v_rcp_f32 v101, v101
    v_rcp_f32 v102, v102
    v_rcp_f32 v103, v103
    v_mul_f32 v96, v180, v96
    v_mul_f32 v97, v181, v97
    v_mul_f32 v98, v182, v98
    v_mul_f32 v99, v183, v99
    s_waitcnt lgkmcnt(6)
    v_mfma_f32_32x32x16_bf16 v[160:175], v[140:143], v[36:39], v[160:175]
    v_cvt_pk_bf16_f32 v124, v92, v93
    v_cvt_pk_bf16_f32 v125, v94, v95
    v_rcp_f32 v104, v104
    v_rcp_f32 v105, v105
    ds_read_b32 v10, v1 offset:768
    ds_read_b32 v2, v21 offset:768
    ds_read_b32 v4, v21 offset:800
    ds_read_b32 v6, v21 offset:832
    ds_read_b32 v8, v21 offset:864
    ds_read_b32 v17, v1 offset:6144
    v_rcp_f32 v106, v106
    v_rcp_f32 v107, v107
    v_mul_f32 v100, v184, v100
    v_mul_f32 v101, v185, v101
    v_mul_f32 v102, v186, v102
    v_mul_f32 v103, v187, v103
    v_cvt_pk_bf16_f32 v126, v96, v97
    v_cvt_pk_bf16_f32 v127, v98, v99
    v_mul_f32 v104, v188, v104
    v_mul_f32 v105, v189, v105
    s_waitcnt lgkmcnt(10)
    v_mfma_f32_32x32x16_bf16 v[60:75], v[124:127], v[144:147], v[60:75]
    v_mul_f32 v106, v190, v106
    v_mul_f32 v107, v191, v107
    v_cvt_pk_bf16_f32 v128, v100, v101
    v_cvt_pk_bf16_f32 v129, v102, v103
    v_cvt_pk_bf16_f32 v130, v104, v105
    v_cvt_pk_bf16_f32 v131, v106, v107
    v_exp_f32 v92, v160
    v_exp_f32 v93, v161
    s_waitcnt lgkmcnt(8)
    v_mfma_f32_32x32x16_bf16 v[60:75], v[128:131], v[148:151], v[60:75]
    v_exp_f32 v94, v162
    v_exp_f32 v95, v163
    s_waitcnt lgkmcnt(0)
    v_add_u32 v17, v16, v17
    v_exp_f32 v96, v164
    v_exp_f32 v97, v165
    v_exp_f32 v98, v166
    s_waitcnt vmcnt(5)
    v_mfma_f32_32x32x16_bf16 v[176:191], v[152:155], v[48:51], 0
    ds_read_b128 v[152:155], v12 offset:16384
    v_exp_f32 v99, v167
    v_exp_f32 v100, v168
    ds_read2_b32 v[18:19], v255 offset0:96 offset1:104
    ds_read2_b32 v[22:23], v255 offset0:112 offset1:120
    v_exp_f32 v101, v169
    v_exp_f32 v102, v170
    v_exp_f32 v103, v171
    v_mfma_f32_32x32x16_bf16 v[176:191], v[156:159], v[52:55], v[176:191]
    ds_read_b128 v[156:159], v13 offset:16384
    v_exp_f32 v104, v172
    v_exp_f32 v105, v173
    s_add_u32 m0, s39, 0
    v_exp_f32 v106, v174
    buffer_load_dwordx4 v[2:3], s[84:87], 0 idxen offen lds
    v_exp_f32 v107, v175
    v_rcp_f32 v108, v108
    v_rcp_f32 v109, v109
    v_mfma_f32_32x32x16_bf16 v[92:107], v[56:59], v[56:59], v[92:107]
    v_rcp_f32 v110, v110
    v_rcp_f32 v111, v111
    s_add_u32 m0, s39, 1024
    v_rcp_f32 v112, v112
    buffer_load_dwordx4 v[4:5], s[84:87], 0 idxen offen lds
    v_rcp_f32 v113, v113
    v_rcp_f32 v114, v114
    v_mfma_f32_32x32x16_bf16 v[176:191], v[132:135], v[28:31], v[176:191]
    v_rcp_f32 v115, v115
    v_mul_f32 v108, v192, v108
    v_mul_f32 v109, v193, v109
    s_add_u32 m0, s39, 2048
    v_mul_f32 v110, v194, v110
    buffer_load_dwordx4 v[6:7], s[84:87], 0 idxen offen lds
    v_mul_f32 v111, v195, v111
    v_rcp_f32 v116, v116
    v_mfma_f32_32x32x16_bf16 v[176:191], v[136:139], v[40:43], v[176:191]
    ds_read_b128 v[136:139], v17 offset:0
    v_rcp_f32 v117, v117
    v_rcp_f32 v118, v118
    v_rcp_f32 v119, v119
    v_mul_f32 v112, v196, v112
    s_add_u32 m0, s39, 3072
    v_mul_f32 v113, v197, v113
    buffer_load_dwordx4 v[8:9], s[84:87], 0 idxen offen lds
    v_mul_f32 v114, v198, v114
    v_mul_f32 v115, v199, v115
    v_mfma_f32_32x32x16_bf16 v[176:191], v[140:143], v[44:47], v[176:191]
    ds_read_b128 v[140:143], v17 offset:32
    v_cvt_pk_bf16_f32 v124, v108, v109
    v_cvt_pk_bf16_f32 v125, v110, v111
    v_rcp_f32 v120, v120
    v_rcp_f32 v121, v121
    v_rcp_f32 v122, v122
    buffer_load_dwordx4 v[132:135], v[10:11], s[12:15], 0 idxen offen
    v_rcp_f32 v123, v123
    v_mul_f32 v116, v200, v116
    v_mul_f32 v117, v201, v117
    v_mul_f32 v118, v202, v118
    v_mul_f32 v119, v203, v119
    v_cvt_pk_bf16_f32 v126, v112, v113
    v_cvt_pk_bf16_f32 v127, v114, v115
    v_mul_f32 v120, v204, v120
    v_mul_f32 v121, v205, v121
    v_mfma_f32_32x32x16_bf16 v[76:91], v[124:127], v[144:147], v[76:91]
    v_mul_f32 v122, v206, v122
    v_mul_f32 v123, v207, v123
    s_waitcnt lgkmcnt(4)
    v_add_u32 v18, v20, v18
    v_add_u32 v19, v20, v19
    s_waitcnt lgkmcnt(3)
    v_add_u32 v22, v20, v22
    v_add_u32 v23, v20, v23
    v_cvt_pk_bf16_f32 v128, v116, v117
    v_cvt_pk_bf16_f32 v129, v118, v119
    v_cvt_pk_bf16_f32 v130, v120, v121
    v_cvt_pk_bf16_f32 v131, v122, v123
    s_sub_u32 s38, s38, 1
    v_add_u32 v21, 384, v21
    v_add_u32 v1, 384, v1
    v_add_u32 v255, 384, v255
    s_branch K2_LOOP
K2_TAIL0:
    s_setprio 0
    s_waitcnt lgkmcnt(0)
    s_or_b32 s42, s56, s57
    s_or_b32 s42, s42, s58
    s_cmp_lg_u32 s42, 0
    s_cbranch_scc1 K2_NOW2_0
    v_and_b32 v248, 63, v0
    s_lshl_b32 s42, s32, 14
    v_lshl_add_u32 v248, v248, 4, s42
    s_mov_b32 s42, 139264
    buffer_load_dwordx4 v[208:211], v248, s[16:19], s42 offen offset:0
    buffer_load_dwordx4 v[212:215], v248, s[16:19], s42 offen offset:1024
    buffer_load_dwordx4 v[216:219], v248, s[16:19], s42 offen offset:2048
    buffer_load_dwordx4 v[220:223], v248, s[16:19], s42 offen offset:3072
    s_mov_b32 s42, 143360
    buffer_load_dwordx4 v[224:227], v248, s[16:19], s42 offen offset:0
    buffer_load_dwordx4 v[228:231], v248, s[16:19], s42 offen offset:1024
    buffer_load_dwordx4 v[232:235], v248, s[16:19], s42 offen offset:2048
    buffer_load_dwordx4 v[236:239], v248, s[16:19], s42 offen offset:3072
    s_mov_b32 s42, 147456
    buffer_load_dwordx4 v[240:243], v248, s[16:19], s42 offen offset:0
    buffer_load_dwordx4 v[152:155], v248, s[16:19], s42 offen offset:1024
    buffer_load_dwordx4 v[156:159], v248, s[16:19], s42 offen offset:2048
    buffer_load_dwordx4 v[132:135], v248, s[16:19], s42 offen offset:3072
    s_mov_b32 s42, 151552
    buffer_load_dwordx4 v[136:139], v248, s[16:19], s42 offen offset:0
    buffer_load_dwordx4 v[140:143], v248, s[16:19], s42 offen offset:1024
    buffer_load_dwordx4 v[24:27], v248, s[16:19], s42 offen offset:2048
    buffer_load_dwordx4 v[28:31], v248, s[16:19], s42 offen offset:3072
    v_and_b32 v250, 63, v0
    v_lshrrev_b32 v250, 5, v250
    s_lshl_b32 s42, s32, 7
    v_lshl_add_u32 v250, v250, 6, s42
    s_mov_b32 s42, 205824
    buffer_load_dwordx4 v[32:35], v250, s[16:19], s42 offen offset:0
    buffer_load_dwordx4 v[36:39], v250, s[16:19], s42 offen offset:16
    buffer_load_dwordx4 v[40:43], v250, s[16:19], s42 offen offset:32
    buffer_load_dwordx4 v[44:47], v250, s[16:19], s42 offen offset:48
    s_mov_b32 s60, 1
K2_NOW2_0:
    v_exp_f32 v108, v176
    v_exp_f32 v109, v177
    v_mfma_f32_32x32x16_bf16 v[76:91], v[128:131], v[148:151], v[76:91]
    ds_read_b64_tr_b16 v[144:145], v18
    ds_read_b64_tr_b16 v[146:147], v19
    ds_read_b64_tr_b16 v[148:149], v22
    ds_read_b64_tr_b16 v[150:151], v23
    v_exp_f32 v110, v178
    v_exp_f32 v111, v179
    v_exp_f32 v112, v180
    v_exp_f32 v113, v181
    v_exp_f32 v114, v182
    v_exp_f32 v115, v183
    v_exp_f32 v116, v184
    v_exp_f32 v117, v185
    v_exp_f32 v118, v186
    v_exp_f32 v119, v187
    v_exp_f32 v120, v188
    v_exp_f32 v121, v189
    v_exp_f32 v122, v190
    v_exp_f32 v123, v191
    v_rcp_f32 v92, v92
    v_rcp_f32 v93, v93
    v_mfma_f32_32x32x16_bf16 v[108:123], v[56:59], v[56:59], v[108:123]
    v_rcp_f32 v94, v94
    v_rcp_f32 v95, v95
    v_rcp_f32 v96, v96
    v_rcp_f32 v97, v97
    v_rcp_f32 v98, v98
    v_rcp_f32 v99, v99
    v_mul_f32 v92, v160, v92
    v_mul_f32 v93, v161, v93
    v_mul_f32 v94, v162, v94
    v_mul_f32 v95, v163, v95
    v_rcp_f32 v100, v100
    v_rcp_f32 v101, v101
    v_rcp_f32 v102, v102
    v_rcp_f32 v103, v103
    v_mul_f32 v96, v164, v96
    v_mul_f32 v97, v165, v97
    v_mul_f32 v98, v166, v98
    v_mul_f32 v99, v167, v99
    v_cvt_pk_bf16_f32 v124, v92, v93
    v_cvt_pk_bf16_f32 v125, v94, v95
    v_rcp_f32 v104, v104
    v_rcp_f32 v105, v105
    v_rcp_f32 v106, v106
    v_rcp_f32 v107, v107
    v_mul_f32 v100, v168, v100
    v_mul_f32 v101, v169, v101
    v_mul_f32 v102, v170, v102
    v_mul_f32 v103, v171, v103
    v_cvt_pk_bf16_f32 v126, v96, v97
    v_cvt_pk_bf16_f32 v127, v98, v99
    v_mul_f32 v104, v172, v104
    v_mul_f32 v105, v173, v105
    s_waitcnt lgkmcnt(2)
    v_mfma_f32_32x32x16_bf16 v[60:75], v[124:127], v[144:147], v[60:75]
    v_mul_f32 v106, v174, v106
    v_mul_f32 v107, v175, v107
    v_cvt_pk_bf16_f32 v128, v100, v101
    v_cvt_pk_bf16_f32 v129, v102, v103
    v_cvt_pk_bf16_f32 v130, v104, v105
    v_cvt_pk_bf16_f32 v131, v106, v107
    v_rcp_f32 v108, v108
    v_rcp_f32 v109, v109
    s_waitcnt lgkmcnt(0)
    v_mfma_f32_32x32x16_bf16 v[60:75], v[128:131], v[148:151], v[60:75]
    v_rcp_f32 v110, v110
    v_rcp_f32 v111, v111
    v_rcp_f32 v112, v112
    v_rcp_f32 v113, v113
    v_rcp_f32 v114, v114
    v_rcp_f32 v115, v115
    v_mul_f32 v108, v176, v108
    v_mul_f32 v109, v177, v109
    v_mul_f32 v110, v178, v110
    v_mul_f32 v111, v179, v111
    v_rcp_f32 v116, v116
    v_rcp_f32 v117, v117
    v_rcp_f32 v118, v118
    v_rcp_f32 v119, v119
    v_mul_f32 v112, v180, v112
    v_mul_f32 v113, v181, v113
    v_mul_f32 v114, v182, v114
    v_mul_f32 v115, v183, v115
    v_cvt_pk_bf16_f32 v124, v108, v109
    v_cvt_pk_bf16_f32 v125, v110, v111
    v_rcp_f32 v120, v120
    v_rcp_f32 v121, v121
    v_rcp_f32 v122, v122
    v_rcp_f32 v123, v123
    v_mul_f32 v116, v184, v116
    v_mul_f32 v117, v185, v117
    v_mul_f32 v118, v186, v118
    v_mul_f32 v119, v187, v119
    v_cvt_pk_bf16_f32 v126, v112, v113
    v_cvt_pk_bf16_f32 v127, v114, v115
    v_mul_f32 v120, v188, v120
    v_mul_f32 v121, v189, v121
    v_mfma_f32_32x32x16_bf16 v[76:91], v[124:127], v[144:147], v[76:91]
    v_mul_f32 v122, v190, v122
    v_mul_f32 v123, v191, v123
    v_cvt_pk_bf16_f32 v128, v116, v117
    v_cvt_pk_bf16_f32 v129, v118, v119
    v_cvt_pk_bf16_f32 v130, v120, v121
    v_cvt_pk_bf16_f32 v131, v122, v123
    s_nop 1
    v_mfma_f32_32x32x16_bf16 v[76:91], v[128:131], v[148:151], v[76:91]
    s_branch K2_AFTER
K2_TAIL1:
    s_setprio 0
    s_waitcnt lgkmcnt(0)
    s_or_b32 s42, s56, s57
    s_or_b32 s42, s42, s58
    s_cmp_lg_u32 s42, 0
    s_cbranch_scc1 K2_NOW2_1
    v_and_b32 v248, 63, v0
    s_lshl_b32 s42, s32, 14
    v_lshl_add_u32 v248, v248, 4, s42
    s_mov_b32 s42, 139264
    buffer_load_dwordx4 v[208:211], v248, s[16:19], s42 offen offset:0
    buffer_load_dwordx4 v[212:215], v248, s[16:19], s42 offen offset:1024
    buffer_load_dwordx4 v[216:219], v248, s[16:19], s42 offen offset:2048
    buffer_load_dwordx4 v[220:223], v248, s[16:19], s42 offen offset:3072
    s_mov_b32 s42, 143360
    buffer_load_dwordx4 v[224:227], v248, s[16:19], s42 offen offset:0
    buffer_load_dwordx4 v[228:231], v248, s[16:19], s42 offen offset:1024
    buffer_load_dwordx4 v[232:235], v248, s[16:19], s42 offen offset:2048
    buffer_load_dwordx4 v[236:239], v248, s[16:19], s42 offen offset:3072
    s_mov_b32 s42, 147456
    buffer_load_dwordx4 v[240:243], v248, s[16:19], s42 offen offset:0
    buffer_load_dwordx4 v[152:155], v248, s[16:19], s42 offen offset:1024
    buffer_load_dwordx4 v[156:159], v248, s[16:19], s42 offen offset:2048
    buffer_load_dwordx4 v[132:135], v248, s[16:19], s42 offen offset:3072
    s_mov_b32 s42, 151552
    buffer_load_dwordx4 v[136:139], v248, s[16:19], s42 offen offset:0
    buffer_load_dwordx4 v[140:143], v248, s[16:19], s42 offen offset:1024
    buffer_load_dwordx4 v[24:27], v248, s[16:19], s42 offen offset:2048
    buffer_load_dwordx4 v[28:31], v248, s[16:19], s42 offen offset:3072
    v_and_b32 v250, 63, v0
    v_lshrrev_b32 v250, 5, v250
    s_lshl_b32 s42, s32, 7
    v_lshl_add_u32 v250, v250, 6, s42
    s_mov_b32 s42, 205824
    buffer_load_dwordx4 v[32:35], v250, s[16:19], s42 offen offset:0
    buffer_load_dwordx4 v[36:39], v250, s[16:19], s42 offen offset:16
    buffer_load_dwordx4 v[40:43], v250, s[16:19], s42 offen offset:32
    buffer_load_dwordx4 v[44:47], v250, s[16:19], s42 offen offset:48
    s_mov_b32 s60, 1
K2_NOW2_1:
    v_exp_f32 v108, v160
    v_exp_f32 v109, v161
    v_mfma_f32_32x32x16_bf16 v[76:91], v[128:131], v[148:151], v[76:91]
    ds_read_b64_tr_b16 v[144:145], v18
    ds_read_b64_tr_b16 v[146:147], v19
    ds_read_b64_tr_b16 v[148:149], v22
    ds_read_b64_tr_b16 v[150:151], v23
    v_exp_f32 v110, v162
    v_exp_f32 v111, v163
    v_exp_f32 v112, v164
    v_exp_f32 v113, v165
    v_exp_f32 v114, v166
    v_exp_f32 v115, v167
    v_exp_f32 v116, v168
    v_exp_f32 v117, v169
    v_exp_f32 v118, v170
    v_exp_f32 v119, v171
    v_exp_f32 v120, v172
    v_exp_f32 v121, v173
    v_exp_f32 v122, v174
    v_exp_f32 v123, v175
    v_rcp_f32 v92, v92
    v_rcp_f32 v93, v93
    v_mfma_f32_32x32x16_bf16 v[108:123], v[56:59], v[56:59], v[108:123]
    v_rcp_f32 v94, v94
    v_rcp_f32 v95, v95
    v_rcp_f32 v96, v96
    v_rcp_f32 v97, v97
    v_rcp_f32 v98, v98
    v_rcp_f32 v99, v99
    v_mul_f32 v92, v192, v92
    v_mul_f32 v93, v193, v93
    v_mul_f32 v94, v194, v94
    v_mul_f32 v95, v195, v95
    v_rcp_f32 v100, v100
    v_rcp_f32 v101, v101
    v_rcp_f32 v102, v102
    v_rcp_f32 v103, v103
    v_mul_f32 v96, v196, v96
    v_mul_f32 v97, v197, v97
    v_mul_f32 v98, v198, v98
    v_mul_f32 v99, v199, v99
    v_cvt_pk_bf16_f32 v124, v92, v93
    v_cvt_pk_bf16_f32 v125, v94, v95
    v_rcp_f32 v104, v104
    v_rcp_f32 v105, v105
    v_rcp_f32 v106, v106
    v_rcp_f32 v107, v107
    v_mul_f32 v100, v200, v100
    v_mul_f32 v101, v201, v101
    v_mul_f32 v102, v202, v102
    v_mul_f32 v103, v203, v103
    v_cvt_pk_bf16_f32 v126, v96, v97
    v_cvt_pk_bf16_f32 v127, v98, v99
    v_mul_f32 v104, v204, v104
    v_mul_f32 v105, v205, v105
    s_waitcnt lgkmcnt(2)
    v_mfma_f32_32x32x16_bf16 v[60:75], v[124:127], v[144:147], v[60:75]
    v_mul_f32 v106, v206, v106
    v_mul_f32 v107, v207, v107
    v_cvt_pk_bf16_f32 v128, v100, v101
    v_cvt_pk_bf16_f32 v129, v102, v103
    v_cvt_pk_bf16_f32 v130, v104, v105
    v_cvt_pk_bf16_f32 v131, v106, v107
    v_rcp_f32 v108, v108
    v_rcp_f32 v109, v109
    s_waitcnt lgkmcnt(0)
    v_mfma_f32_32x32x16_bf16 v[60:75], v[128:131], v[148:151], v[60:75]
    v_rcp_f32 v110, v110
    v_rcp_f32 v111, v111
    v_rcp_f32 v112, v112
    v_rcp_f32 v113, v113
    v_rcp_f32 v114, v114
    v_rcp_f32 v115, v115
    v_mul_f32 v108, v160, v108
    v_mul_f32 v109, v161, v109
    v_mul_f32 v110, v162, v110
    v_mul_f32 v111, v163, v111
    v_rcp_f32 v116, v116
    v_rcp_f32 v117, v117
    v_rcp_f32 v118, v118
    v_rcp_f32 v119, v119
    v_mul_f32 v112, v164, v112
    v_mul_f32 v113, v165, v113
    v_mul_f32 v114, v166, v114
    v_mul_f32 v115, v167, v115
    v_cvt_pk_bf16_f32 v124, v108, v109
    v_cvt_pk_bf16_f32 v125, v110, v111
    v_rcp_f32 v120, v120
    v_rcp_f32 v121, v121
    v_rcp_f32 v122, v122
    v_rcp_f32 v123, v123
    v_mul_f32 v116, v168, v116
    v_mul_f32 v117, v169, v117
    v_mul_f32 v118, v170, v118
    v_mul_f32 v119, v171, v119
    v_cvt_pk_bf16_f32 v126, v112, v113
    v_cvt_pk_bf16_f32 v127, v114, v115
    v_mul_f32 v120, v172, v120
    v_mul_f32 v121, v173, v121
    v_mfma_f32_32x32x16_bf16 v[76:91], v[124:127], v[144:147], v[76:91]
    v_mul_f32 v122, v174, v122
    v_mul_f32 v123, v175, v123
    v_cvt_pk_bf16_f32 v128, v116, v117
    v_cvt_pk_bf16_f32 v129, v118, v119
    v_cvt_pk_bf16_f32 v130, v120, v121
    v_cvt_pk_bf16_f32 v131, v122, v123
    s_nop 1
    v_mfma_f32_32x32x16_bf16 v[76:91], v[128:131], v[148:151], v[76:91]
    s_branch K2_AFTER
K2_TAIL2:
    s_setprio 0
    s_waitcnt lgkmcnt(0)
    s_or_b32 s42, s56, s57
    s_or_b32 s42, s42, s58
    s_cmp_lg_u32 s42, 0
    s_cbranch_scc1 K2_NOW2_2
    v_and_b32 v248, 63, v0
    s_lshl_b32 s42, s32, 14
    v_lshl_add_u32 v248, v248, 4, s42
    s_mov_b32 s42, 139264
    buffer_load_dwordx4 v[208:211], v248, s[16:19], s42 offen offset:0
    buffer_load_dwordx4 v[212:215], v248, s[16:19], s42 offen offset:1024
    buffer_load_dwordx4 v[216:219], v248, s[16:19], s42 offen offset:2048
    buffer_load_dwordx4 v[220:223], v248, s[16:19], s42 offen offset:3072
    s_mov_b32 s42, 143360
    buffer_load_dwordx4 v[224:227], v248, s[16:19], s42 offen offset:0
    buffer_load_dwordx4 v[228:231], v248, s[16:19], s42 offen offset:1024
    buffer_load_dwordx4 v[232:235], v248, s[16:19], s42 offen offset:2048
    buffer_load_dwordx4 v[236:239], v248, s[16:19], s42 offen offset:3072
    s_mov_b32 s42, 147456
    buffer_load_dwordx4 v[240:243], v248, s[16:19], s42 offen offset:0
    buffer_load_dwordx4 v[152:155], v248, s[16:19], s42 offen offset:1024
    buffer_load_dwordx4 v[156:159], v248, s[16:19], s42 offen offset:2048
    buffer_load_dwordx4 v[132:135], v248, s[16:19], s42 offen offset:3072
    s_mov_b32 s42, 151552
    buffer_load_dwordx4 v[136:139], v248, s[16:19], s42 offen offset:0
    buffer_load_dwordx4 v[140:143], v248, s[16:19], s42 offen offset:1024
    buffer_load_dwordx4 v[24:27], v248, s[16:19], s42 offen offset:2048
    buffer_load_dwordx4 v[28:31], v248, s[16:19], s42 offen offset:3072
    v_and_b32 v250, 63, v0
    v_lshrrev_b32 v250, 5, v250
    s_lshl_b32 s42, s32, 7
    v_lshl_add_u32 v250, v250, 6, s42
    s_mov_b32 s42, 205824
    buffer_load_dwordx4 v[32:35], v250, s[16:19], s42 offen offset:0
    buffer_load_dwordx4 v[36:39], v250, s[16:19], s42 offen offset:16
    buffer_load_dwordx4 v[40:43], v250, s[16:19], s42 offen offset:32
    buffer_load_dwordx4 v[44:47], v250, s[16:19], s42 offen offset:48
    s_mov_b32 s60, 1
K2_NOW2_2:
    v_exp_f32 v108, v192
    v_exp_f32 v109, v193
    v_mfma_f32_32x32x16_bf16 v[76:91], v[128:131], v[148:151], v[76:91]
    ds_read_b64_tr_b16 v[144:145], v18
    ds_read_b64_tr_b16 v[146:147], v19
    ds_read_b64_tr_b16 v[148:149], v22
    ds_read_b64_tr_b16 v[150:151], v23
    v_exp_f32 v110, v194
    v_exp_f32 v111, v195
    v_exp_f32 v112, v196
    v_exp_f32 v113, v197
    v_exp_f32 v114, v198
    v_exp_f32 v115, v199
    v_exp_f32 v116, v200
    v_exp_f32 v117, v201
    v_exp_f32 v118, v202
    v_exp_f32 v119, v203
    v_exp_f32 v120, v204
    v_exp_f32 v121, v205
    v_exp_f32 v122, v206
    v_exp_f32 v123, v207
    v_rcp_f32 v92, v92
    v_rcp_f32 v93, v93
    v_mfma_f32_32x32x16_bf16 v[108:123], v[56:59], v[56:59], v[108:123]
    v_rcp_f32 v94, v94
    v_rcp_f32 v95, v95
    v_rcp_f32 v96, v96
    v_rcp_f32 v97, v97
    v_rcp_f32 v98, v98
    v_rcp_f32 v99, v99
    v_mul_f32 v92, v176, v92
    v_mul_f32 v93, v177, v93
    v_mul_f32 v94, v178, v94
    v_mul_f32 v95, v179, v95
    v_rcp_f32 v100, v100
    v_rcp_f32 v101, v101
    v_rcp_f32 v102, v102
    v_rcp_f32 v103, v103
    v_mul_f32 v96, v180, v96
    v_mul_f32 v97, v181, v97
    v_mul_f32 v98, v182, v98
    v_mul_f32 v99, v183, v99
    v_cvt_pk_bf16_f32 v124, v92, v93
    v_cvt_pk_bf16_f32 v125, v94, v95
    v_rcp_f32 v104, v104
    v_rcp_f32 v105, v105
    v_rcp_f32 v106, v106
    v_rcp_f32 v107, v107
    v_mul_f32 v100, v184, v100
    v_mul_f32 v101, v185, v101
    v_mul_f32 v102, v186, v102
    v_mul_f32 v103, v187, v103
    v_cvt_pk_bf16_f32 v126, v96, v97
    v_cvt_pk_bf16_f32 v127, v98, v99
    v_mul_f32 v104, v188, v104
    v_mul_f32 v105, v189, v105
    s_waitcnt lgkmcnt(2)
    v_mfma_f32_32x32x16_bf16 v[60:75], v[124:127], v[144:147], v[60:75]
    v_mul_f32 v106, v190, v106
    v_mul_f32 v107, v191, v107
    v_cvt_pk_bf16_f32 v128, v100, v101
    v_cvt_pk_bf16_f32 v129, v102, v103
    v_cvt_pk_bf16_f32 v130, v104, v105
    v_cvt_pk_bf16_f32 v131, v106, v107
    v_rcp_f32 v108, v108
    v_rcp_f32 v109, v109
    s_waitcnt lgkmcnt(0)
    v_mfma_f32_32x32x16_bf16 v[60:75], v[128:131], v[148:151], v[60:75]
    v_rcp_f32 v110, v110
    v_rcp_f32 v111, v111
    v_rcp_f32 v112, v112
    v_rcp_f32 v113, v113
    v_rcp_f32 v114, v114
    v_rcp_f32 v115, v115
    v_mul_f32 v108, v192, v108
    v_mul_f32 v109, v193, v109
    v_mul_f32 v110, v194, v110
    v_mul_f32 v111, v195, v111
    v_rcp_f32 v116, v116
    v_rcp_f32 v117, v117
    v_rcp_f32 v118, v118
    v_rcp_f32 v119, v119
    v_mul_f32 v112, v196, v112
    v_mul_f32 v113, v197, v113
    v_mul_f32 v114, v198, v114
    v_mul_f32 v115, v199, v115
    v_cvt_pk_bf16_f32 v124, v108, v109
    v_cvt_pk_bf16_f32 v125, v110, v111
    v_rcp_f32 v120, v120
    v_rcp_f32 v121, v121
    v_rcp_f32 v122, v122
    v_rcp_f32 v123, v123
    v_mul_f32 v116, v200, v116
    v_mul_f32 v117, v201, v117
    v_mul_f32 v118, v202, v118
    v_mul_f32 v119, v203, v119
    v_cvt_pk_bf16_f32 v126, v112, v113
    v_cvt_pk_bf16_f32 v127, v114, v115
    v_mul_f32 v120, v204, v120
    v_mul_f32 v121, v205, v121
    v_mfma_f32_32x32x16_bf16 v[76:91], v[124:127], v[144:147], v[76:91]
    v_mul_f32 v122, v206, v122
    v_mul_f32 v123, v207, v123
    v_cvt_pk_bf16_f32 v128, v116, v117
    v_cvt_pk_bf16_f32 v129, v118, v119
    v_cvt_pk_bf16_f32 v130, v120, v121
    v_cvt_pk_bf16_f32 v131, v122, v123
    s_nop 1
    v_mfma_f32_32x32x16_bf16 v[76:91], v[128:131], v[148:151], v[76:91]
K2_AFTER:
    s_waitcnt lgkmcnt(0)
    s_or_b32 s42, s56, s57
    s_or_b32 s42, s42, s58
    s_cmp_lg_u32 s42, 0
    s_cbranch_scc1 K2_SLOW
    s_cmp_lg_u32 s60, 0
    s_cbranch_scc1 K2_EPI
    v_and_b32 v248, 63, v0
    s_lshl_b32 s42, s32, 14
    v_lshl_add_u32 v248, v248, 4, s42
    s_mov_b32 s42, 139264
    buffer_load_dwordx4 v[208:211], v248, s[16:19], s42 offen offset:0
    buffer_load_dwordx4 v[212:215], v248, s[16:19], s42 offen offset:1024
    buffer_load_dwordx4 v[216:219], v248, s[16:19], s42 offen offset:2048
    buffer_load_dwordx4 v[220:223], v248, s[16:19], s42 offen offset:3072
    s_mov_b32 s42, 143360
    buffer_load_dwordx4 v[224:227], v248, s[16:19], s42 offen offset:0
    buffer_load_dwordx4 v[228:231], v248, s[16:19], s42 offen offset:1024
    buffer_load_dwordx4 v[232:235], v248, s[16:19], s42 offen offset:2048
    buffer_load_dwordx4 v[236:239], v248, s[16:19], s42 offen offset:3072
    s_mov_b32 s42, 147456
    buffer_load_dwordx4 v[240:243], v248, s[16:19], s42 offen offset:0
    buffer_load_dwordx4 v[152:155], v248, s[16:19], s42 offen offset:1024
    buffer_load_dwordx4 v[156:159], v248, s[16:19], s42 offen offset:2048
    buffer_load_dwordx4 v[132:135], v248, s[16:19], s42 offen offset:3072
    s_mov_b32 s42, 151552
    buffer_load_dwordx4 v[136:139], v248, s[16:19], s42 offen offset:0
    buffer_load_dwordx4 v[140:143], v248, s[16:19], s42 offen offset:1024
    buffer_load_dwordx4 v[24:27], v248, s[16:19], s42 offen offset:2048
    buffer_load_dwordx4 v[28:31], v248, s[16:19], s42 offen offset:3072
    v_and_b32 v250, 63, v0
    v_lshrrev_b32 v250, 5, v250
    s_lshl_b32 s42, s32, 7
    v_lshl_add_u32 v250, v250, 6, s42
    s_mov_b32 s42, 205824
    buffer_load_dwordx4 v[32:35], v250, s[16:19], s42 offen offset:0
    buffer_load_dwordx4 v[36:39], v250, s[16:19], s42 offen offset:16
    buffer_load_dwordx4 v[40:43], v250, s[16:19], s42 offen offset:32
    buffer_load_dwordx4 v[44:47], v250, s[16:19], s42 offen offset:48
    s_mov_b32 s60, 1
K2_EPI:
    v_and_b32 v249, 63, v0
    v_and_b32 v251, 31, v249
    v_lshlrev_b32 v252, 2, v251
    ds_read_b32 v253, v252 offset:0
    s_mov_b32 s42, 0xbf317218
    s_nop 7
    v_mul_f32 v60, s42, v60
    v_mul_f32 v61, s42, v61
    v_mul_f32 v62, s42, v62
    v_mul_f32 v63, s42, v63
    v_mul_f32 v64, s42, v64
    v_mul_f32 v65, s42, v65
    v_mul_f32 v66, s42, v66
    v_mul_f32 v67, s42, v67
    v_mul_f32 v68, s42, v68
    v_mul_f32 v69, s42, v69
    v_mul_f32 v70, s42, v70
    v_mul_f32 v71, s42, v71
    v_mul_f32 v72, s42, v72
    v_mul_f32 v73, s42, v73
    v_mul_f32 v74, s42, v74
    v_mul_f32 v75, s42, v75
    v_mul_f32 v76, s42, v76
    v_mul_f32 v77, s42, v77
    v_mul_f32 v78, s42, v78
    v_mul_f32 v79, s42, v79
    v_mul_f32 v80, s42, v80
    v_mul_f32 v81, s42, v81
    v_mul_f32 v82, s42, v82
    v_mul_f32 v83, s42, v83
    v_mul_f32 v84, s42, v84
    v_mul_f32 v85, s42, v85
    v_mul_f32 v86, s42, v86
    v_mul_f32 v87, s42, v87
    v_mul_f32 v88, s42, v88
    v_mul_f32 v89, s42, v89
    v_mul_f32 v90, s42, v90
    v_mul_f32 v91, s42, v91
    v_cvt_pk_bf16_f32 v92, v60, v61
    v_cvt_pk_bf16_f32 v93, v62, v63
    v_cvt_pk_bf16_f32 v94, v64, v65
    v_cvt_pk_bf16_f32 v95, v66, v67
    v_cvt_pk_bf16_f32 v96, v68, v69
    v_cvt_pk_bf16_f32 v97, v70, v71
    v_cvt_pk_bf16_f32 v98, v72, v73
    v_cvt_pk_bf16_f32 v99, v74, v75
    v_cvt_pk_bf16_f32 v100, v76, v77
    v_cvt_pk_bf16_f32 v101, v78, v79
    v_cvt_pk_bf16_f32 v102, v80, v81
    v_cvt_pk_bf16_f32 v103, v82, v83
    v_cvt_pk_bf16_f32 v104, v84, v85
    v_cvt_pk_bf16_f32 v105, v86, v87
    v_cvt_pk_bf16_f32 v106, v88, v89
    v_cvt_pk_bf16_f32 v107, v90, v91
    s_lshl_b32 s42, s32, 12
    v_lshl_add_u32 v252, v249, 4, s42
    s_waitcnt vmcnt(20)
    ds_write_b128 v252, v[92:95] offset:19712
    ds_write_b128 v252, v[96:99] offset:20736
    ds_write_b128 v252, v[100:103] offset:21760
    ds_write_b128 v252, v[104:107] offset:22784
    s_waitcnt lgkmcnt(0)
    s_barrier
    v_lshlrev_b32 v252, 4, v249
    ds_read_b128 v[60:63], v252 offset:19712
    ds_read_b128 v[64:67], v252 offset:20736
    ds_read_b128 v[68:71], v252 offset:21760
    ds_read_b128 v[72:75], v252 offset:22784
    ds_read_b128 v[76:79], v252 offset:23808
    ds_read_b128 v[80:83], v252 offset:24832
    ds_read_b128 v[84:87], v252 offset:25856
    ds_read_b128 v[88:91], v252 offset:26880
    ds_read_b128 v[176:179], v252 offset:27904
    ds_read_b128 v[180:183], v252 offset:28928
    ds_read_b128 v[184:187], v252 offset:29952
    ds_read_b128 v[188:191], v252 offset:30976
    ds_read_b128 v[192:195], v252 offset:32000
    ds_read_b128 v[196:199], v252 offset:33024
    ds_read_b128 v[200:203], v252 offset:34048
    ds_read_b128 v[204:207], v252 offset:35072
    v_cvt_f32_u32 v253, v253
    s_waitcnt vmcnt(0)
    v_mul_f32 v92, v253, v32
    v_mul_f32 v93, v253, v33
    v_mul_f32 v94, v253, v34
    v_mul_f32 v95, v253, v35
    v_mul_f32 v96, v253, v36
    v_mul_f32 v97, v253, v37
    v_mul_f32 v98, v253, v38
    v_mul_f32 v99, v253, v39
    v_mul_f32 v100, v253, v40
    v_mul_f32 v101, v253, v41
    v_mul_f32 v102, v253, v42
    v_mul_f32 v103, v253, v43
    v_mul_f32 v104, v253, v44
    v_mul_f32 v105, v253, v45
    v_mul_f32 v106, v253, v46
    v_mul_f32 v107, v253, v47
    s_nop 0
    s_waitcnt lgkmcnt(15)
    v_mfma_f32_32x32x16_bf16 v[92:107], v[208:211], v[60:63], v[92:107]
    s_waitcnt lgkmcnt(14)
    v_mfma_f32_32x32x16_bf16 v[92:107], v[212:215], v[64:67], v[92:107]
    s_waitcnt lgkmcnt(13)
    v_mfma_f32_32x32x16_bf16 v[92:107], v[216:219], v[68:71], v[92:107]
    s_waitcnt lgkmcnt(12)
    v_mfma_f32_32x32x16_bf16 v[92:107], v[220:223], v[72:75], v[92:107]
    s_waitcnt lgkmcnt(11)
    v_mfma_f32_32x32x16_bf16 v[92:107], v[224:227], v[76:79], v[92:107]
    s_waitcnt lgkmcnt(10)
    v_mfma_f32_32x32x16_bf16 v[92:107], v[228:231], v[80:83], v[92:107]
    s_waitcnt lgkmcnt(9)
    v_mfma_f32_32x32x16_bf16 v[92:107], v[232:235], v[84:87], v[92:107]
    s_waitcnt lgkmcnt(8)
    v_mfma_f32_32x32x16_bf16 v[92:107], v[236:239], v[88:91], v[92:107]
    s_waitcnt lgkmcnt(7)
    v_mfma_f32_32x32x16_bf16 v[92:107], v[240:243], v[176:179], v[92:107]
    s_waitcnt lgkmcnt(6)
    v_mfma_f32_32x32x16_bf16 v[92:107], v[152:155], v[180:183], v[92:107]
    s_waitcnt lgkmcnt(5)
    v_mfma_f32_32x32x16_bf16 v[92:107], v[156:159], v[184:187], v[92:107]
    s_waitcnt lgkmcnt(4)
    v_mfma_f32_32x32x16_bf16 v[92:107], v[132:135], v[188:191], v[92:107]
    s_waitcnt lgkmcnt(3)
    v_mfma_f32_32x32x16_bf16 v[92:107], v[136:139], v[192:195], v[92:107]
    s_waitcnt lgkmcnt(2)
    v_mfma_f32_32x32x16_bf16 v[92:107], v[140:143], v[196:199], v[92:107]
    s_waitcnt lgkmcnt(1)
    v_mfma_f32_32x32x16_bf16 v[92:107], v[24:27], v[200:203], v[92:107]
    s_waitcnt lgkmcnt(0)
    v_mfma_f32_32x32x16_bf16 v[92:107], v[28:31], v[204:207], v[92:107]
    v_add_u32 v252, s34, v251
    v_lshlrev_b32 v252, 8, v252
    v_lshrrev_b32 v250, 5, v249
    v_lshl_add_u32 v252, v250, 5, v252
    s_lshl_b32 s42, s32, 6
    v_add_u32 v252, s42, v252
    v_cmp_gt_u32 vcc, s35, v251
    v_mov_b32 v250, 0x7f000000
    s_nop 1
    v_cndmask_b32 v252, v250, v252, vcc
    s_nop 4
    v_cvt_pk_bf16_f32 v124, v92, v93
    v_cvt_pk_bf16_f32 v125, v94, v95
    v_cvt_pk_bf16_f32 v126, v96, v97
    v_cvt_pk_bf16_f32 v127, v98, v99
    v_cvt_pk_bf16_f32 v128, v100, v101
    v_cvt_pk_bf16_f32 v129, v102, v103
    v_cvt_pk_bf16_f32 v130, v104, v105
    v_cvt_pk_bf16_f32 v131, v106, v107
    buffer_store_dwordx4 v[124:127], v252, s[20:23], 0 offen
    buffer_store_dwordx4 v[128:131], v252, s[20:23], 0 offen offset:16
    s_waitcnt vmcnt(0)
    s_endpgm
K2_SLOW:
    s_waitcnt lgkmcnt(0)
    s_barrier
    s_waitcnt vmcnt(0)
    s_ff1_i32_b64 s62, s[56:57]
    s_cmp_lg_u32 s62, -1
    s_cbranch_scc1 K2_SL1
    s_ff1_i32_b32 s62, s58
    s_add_u32 s62, s62, 64
K2_SL1:
    s_mul_i32 s63, s62, 2000
    s_mul_i32 s42, s59, 1000
    s_add_u32 s63, s63, s42
    s_cmp_eq_u32 s59, 0
    s_cbranch_scc1 K2_SL2
    s_cmp_ge_u32 s62, 64
    s_cbranch_scc1 K2_SL3
    s_bitset0_b64 s[56:57], s62
    s_branch K2_SL2
K2_SL3:
    s_sub_u32 s42, s62, 64
    s_bitset0_b32 s58, s42
K2_SL2:
    s_xor_b32 s59, s59, 1
    s_load_dwordx4 s[4:7], s[0:1], 16
    v_mov_b32 v208, 0xffffff
    v_mov_b32 v209, 0xffffff
    v_mov_b32 v210, 0xffffff
    v_mov_b32 v211, 0xffffff
    v_lshlrev_b32 v212, 4, v0
    v_mov_b32 v236, 19520
    v_mov_b32 v237, 19520
    v_mov_b32 v238, 19520
    v_mov_b32 v239, 19520
    ds_write_b128 v212, v[208:211] offset:1024
    ds_write_b128 v212, v[208:211] offset:5120
    ds_write_b128 v212, v[236:239] offset:12288
    v_cmp_gt_u32 vcc, 3072, v212
    s_and_saveexec_b64 s[42:43], vcc
    ds_write_b128 v212, v[208:211] offset:9216
    s_mov_b64 exec, s[42:43]
    v_cmp_gt_u32 vcc, 1536, v212
    s_and_saveexec_b64 s[42:43], vcc
    ds_write_b128 v212, v[236:239] offset:16384
    s_mov_b64 exec, s[42:43]
    v_mov_b32 v213, 128
    v_mov_b32 v214, 0
    ds_write_b32 v213, v214
    s_waitcnt lgkmcnt(0)
    s_mov_b32 s24, s4
    s_mov_b32 s25, s5
    s_mov_b32 s26, 640000
    s_mov_b32 s27, 0x00020000
    s_mov_b32 s28, s6
    s_mov_b32 s29, s7
    s_mov_b32 s30, 640000
    s_mov_b32 s31, 0x00020000
    s_lshl_b32 s42, s63, 2
    buffer_load_dwordx4 v[216:219], v212, s[28:31], s42 offen
    buffer_load_dwordx4 v[220:223], v212, s[24:27], s42 offen
    s_barrier
    s_mov_b32 s42, 429497
    s_movk_i32 s43, 625
    s_waitcnt vmcnt(0)
    v_mul_u32_u24 v224, s42, v216
    v_lshrrev_b32 v224, 23, v224
    v_mul_u32_u24 v225, s42, v217
    v_lshrrev_b32 v225, 23, v225
    v_mul_u32_u24 v226, s42, v218
    v_lshrrev_b32 v226, 23, v226
    v_mul_u32_u24 v227, s42, v219
    v_lshrrev_b32 v227, 23, v227
    v_cmp_gt_u32 vcc, 250, v0
    s_nop 0
    s_mov_b64 s[54:55], vcc
    v_cmp_eq_u32_e64 s[44:45], s33, v224
    s_nop 0
    s_and_b64 s[44:45], s[44:45], s[54:55]
    v_cmp_eq_u32_e64 s[46:47], s33, v225
    s_nop 0
    s_and_b64 s[46:47], s[46:47], s[54:55]
    v_cmp_eq_u32_e64 s[48:49], s33, v226
    s_nop 0
    s_and_b64 s[48:49], s[48:49], s[54:55]
    v_cmp_eq_u32_e64 s[50:51], s33, v227
    s_nop 0
    s_and_b64 s[50:51], s[50:51], s[54:55]
    s_nop 0
    s_bcnt1_i32_b64 s61, s[44:45]
    s_bcnt1_i32_b64 s62, s[46:47]
    s_add_u32 s61, s61, s62
    s_bcnt1_i32_b64 s62, s[48:49]
    s_add_u32 s61, s61, s62
    s_bcnt1_i32_b64 s62, s[50:51]
    s_add_u32 s61, s61, s62
    v_mov_b32 v230, s61
    v_mov_b32 v234, 128
    v_mov_b32 v233, 1
    s_mov_b64 exec, 1
    ds_add_rtn_u32 v231, v234, v230
    s_waitcnt lgkmcnt(0)
    s_mov_b64 exec, -1
    v_readfirstlane_b32 s61, v231
    v_mbcnt_lo_u32_b32 v229, s44, 0
    v_mbcnt_hi_u32_b32 v229, s45, v229
    v_mov_b32 v230, v220
    v_subrev_u32 v231, s34, v216
    v_lshlrev_b32 v232, 2, v0
    v_add_u32 v232, s63, v232
    v_add_u32 v229, s61, v229
    v_lshlrev_b32 v229, 2, v229
    v_lshlrev_b32 v234, 2, v231
    v_mul_u32_u24 v231, 80, v231
    v_add_u32 v231, 17920, v231
    s_mov_b64 exec, s[44:45]
    ds_write_b32 v229, v230 offset:1024
    ds_write_b32 v229, v232 offset:6656
    ds_write_b32 v229, v231 offset:12288
    ds_add_u32 v234, v233 offset:0
    s_mov_b64 exec, -1
    s_bcnt1_i32_b64 s62, s[44:45]
    s_add_u32 s61, s61, s62
    v_mbcnt_lo_u32_b32 v229, s46, 0
    v_mbcnt_hi_u32_b32 v229, s47, v229
    v_mov_b32 v230, v221
    v_subrev_u32 v231, s34, v217
    v_lshlrev_b32 v232, 2, v0
    v_add_u32 v232, s63, v232
    v_add_u32 v232, 1, v232
    v_add_u32 v229, s61, v229
    v_lshlrev_b32 v229, 2, v229
    v_lshlrev_b32 v234, 2, v231
    v_mul_u32_u24 v231, 80, v231
    v_add_u32 v231, 17920, v231
    s_mov_b64 exec, s[46:47]
    ds_write_b32 v229, v230 offset:1024
    ds_write_b32 v229, v232 offset:6656
    ds_write_b32 v229, v231 offset:12288
    ds_add_u32 v234, v233 offset:0
    s_mov_b64 exec, -1
    s_bcnt1_i32_b64 s62, s[46:47]
    s_add_u32 s61, s61, s62
    v_mbcnt_lo_u32_b32 v229, s48, 0
    v_mbcnt_hi_u32_b32 v229, s49, v229
    v_mov_b32 v230, v222
    v_subrev_u32 v231, s34, v218
    v_lshlrev_b32 v232, 2, v0
    v_add_u32 v232, s63, v232
    v_add_u32 v232, 2, v232
    v_add_u32 v229, s61, v229
    v_lshlrev_b32 v229, 2, v229
    v_lshlrev_b32 v234, 2, v231
    v_mul_u32_u24 v231, 80, v231
    v_add_u32 v231, 17920, v231
    s_mov_b64 exec, s[48:49]
    ds_write_b32 v229, v230 offset:1024
    ds_write_b32 v229, v232 offset:6656
    ds_write_b32 v229, v231 offset:12288
    ds_add_u32 v234, v233 offset:0
    s_mov_b64 exec, -1
    s_bcnt1_i32_b64 s62, s[48:49]
    s_add_u32 s61, s61, s62
    v_mbcnt_lo_u32_b32 v229, s50, 0
    v_mbcnt_hi_u32_b32 v229, s51, v229
    v_mov_b32 v230, v223
    v_subrev_u32 v231, s34, v219
    v_lshlrev_b32 v232, 2, v0
    v_add_u32 v232, s63, v232
    v_add_u32 v232, 3, v232
    v_add_u32 v229, s61, v229
    v_lshlrev_b32 v229, 2, v229
    v_lshlrev_b32 v234, 2, v231
    v_mul_u32_u24 v231, 80, v231
    v_add_u32 v231, 17920, v231
    s_mov_b64 exec, s[50:51]
    ds_write_b32 v229, v230 offset:1024
    ds_write_b32 v229, v232 offset:6656
    ds_write_b32 v229, v231 offset:12288
    ds_add_u32 v234, v233 offset:0
    s_mov_b64 exec, -1
    s_waitcnt lgkmcnt(0)
    s_barrier
    v_mov_b32 v234, 128
    ds_read_b32 v230, v234
    v_mov_b32 v21, v246
    v_mov_b32 v1, v247
    v_mov_b32 v255, v245
    v_mov_b32 v3, v244
    v_mov_b32 v193, v244
    v_xor_b32 v5, 64, v244
    v_xor_b32 v195, 64, v244
    v_mov_b32 v7, v244
    v_mov_b32 v197, v244
    v_xor_b32 v9, 64, v244
    v_xor_b32 v199, 64, v244
    v_mov_b32 v201, v11
    ds_read_b32 v10, v247 offset:0
    ds_read_b32 v2, v246 offset:0
    ds_read_b32 v4, v246 offset:32
    ds_read_b32 v6, v246 offset:64
    ds_read_b32 v8, v246 offset:96
    ds_read_b32 v200, v247 offset:128
    ds_read_b32 v192, v246 offset:128
    ds_read_b32 v194, v246 offset:160
    ds_read_b32 v196, v246 offset:192
    ds_read_b32 v198, v246 offset:224
    s_add_u32 m0, s39, 0
    s_waitcnt lgkmcnt(5)
    buffer_load_dwordx4 v[2:3], s[84:87], 0 idxen offen lds
    s_add_u32 m0, s39, 1024
    s_nop 0
    buffer_load_dwordx4 v[4:5], s[84:87], 0 idxen offen lds
    s_add_u32 m0, s39, 2048
    s_nop 0
    buffer_load_dwordx4 v[6:7], s[84:87], 0 idxen offen lds
    s_add_u32 m0, s39, 3072
    s_nop 0
    buffer_load_dwordx4 v[8:9], s[84:87], 0 idxen offen lds
    buffer_load_dwordx4 v[132:135], v[10:11], s[12:15], 0 idxen offen
    v_readfirstlane_b32 s36, v230
    s_add_u32 s37, s36, 31
    s_lshr_b32 s37, s37, 5
    s_add_u32 m0, s39, 16384
    s_waitcnt lgkmcnt(0)
    buffer_load_dwordx4 v[192:193], s[84:87], 0 idxen offen lds
    s_add_u32 m0, s39, 17408
    s_nop 0
    buffer_load_dwordx4 v[194:195], s[84:87], 0 idxen offen lds
    s_add_u32 m0, s39, 18432
    s_nop 0
    buffer_load_dwordx4 v[196:197], s[84:87], 0 idxen offen lds
    s_add_u32 m0, s39, 19456
    s_nop 0
    buffer_load_dwordx4 v[198:199], s[84:87], 0 idxen offen lds
    buffer_load_dwordx4 v[240:243], v[200:201], s[12:15], 0 idxen offen
    s_branch K2_PIPE
K2_PR0_2:
    s_setprio 2
    s_branch K2_PRB0_2
K2_PR0_1:
    s_setprio 1
    s_branch K2_PRB0_1
K2_PR1_2:
    s_setprio 2
    s_branch K2_PRB1_2
K2_PR1_1:
    s_setprio 1
    s_branch K2_PRB1_1
K2_PR2_2:
    s_setprio 2
    s_branch K2_PRB2_2
K2_PR2_1:
    s_setprio 1
    s_branch K2_PRB2_1
K2_EXIT:
    s_endpgm
.section .rodata,"a"
.p2align 6
.amdhsa_kernel k1_bin_prep_kernel
  .amdhsa_next_free_vgpr 156
  .amdhsa_next_free_sgpr 48
  .amdhsa_accum_offset 156
  .amdhsa_group_segment_fixed_size 0
  .amdhsa_kernarg_size 88
  .amdhsa_user_sgpr_count 2
  .amdhsa_user_sgpr_kernarg_segment_ptr 1
  .amdhsa_system_sgpr_workgroup_id_x 1
.end_amdhsa_kernel
.p2align 6
.amdhsa_kernel k2_main_kernel
  .amdhsa_next_free_vgpr 256
  .amdhsa_next_free_sgpr 96
  .amdhsa_accum_offset 256
  .amdhsa_group_segment_fixed_size 0
  .amdhsa_kernarg_size 88
  .amdhsa_user_sgpr_count 2
  .amdhsa_user_sgpr_kernarg_segment_ptr 1
  .amdhsa_system_sgpr_workgroup_id_x 1
.end_amdhsa_kernel
```
